```python
import torch

def _softmax(x, axis=-1):
    return torch.softmax(x, dim=axis)
def _gelu(x):
    return torch.nn.functional.gelu(x, approximate="tanh")
def _silu(x):
    return torch.nn.functional.silu(x)
def _sigmoid(x):
    return torch.sigmoid(x)
def _layernorm(x, axis=-1, eps=1e-5):
    m = x.mean(dim=axis, keepdim=True)
    v = x.var(dim=axis, keepdim=True, unbiased=False)
    return (x - m) / torch.sqrt(v + eps)
def _scatter_add(tgt, idx, src, axis=0):
    return tgt.clone().index_add_(axis, idx, src)
def _segment_sum(src, seg, n):
    out = torch.zeros((n,) + src.shape[1:], dtype=src.dtype)
    return out.index_add_(0, seg, src)
def _pad(x, pw):
    flat = tuple(v for pair in reversed(pw) for v in pair)
    return torch.nn.functional.pad(x, flat)

kernel_name = 'parallel_sum__ssm_conv_s5__dense_activation_gelu__prompt'

def setup_inputs():

    _w = (lambda a: (lambda t: t.to(torch.bfloat16) if t.is_floating_point() else t)(torch.as_tensor(a)))
    def _A_setup():
        B, S, D = 1, 2048, 512
        P = D
        Lambda_re = -0.5 * (lambda _x: torch.exp(torch.as_tensor(_x)))((lambda *s: torch.randn(*s, dtype=torch.bfloat16) * 0.2)(P))
        Lambda_im = (lambda *s: torch.randn(*s, dtype=torch.bfloat16) * 0.8)(P) * 1.0
        B_re = (lambda *s: torch.randn(*s, dtype=torch.bfloat16) * 0.4)(P, D) * (D ** -0.5)
        B_im = (lambda *s: torch.randn(*s, dtype=torch.bfloat16) * 0.4)(P, D) * (D ** -0.5)
        C_re = (lambda *s: torch.randn(*s, dtype=torch.bfloat16) * 0.4)(D, P) * (P ** -0.5)
        C_im = (lambda *s: torch.randn(*s, dtype=torch.bfloat16) * 0.4)(D, P) * (P ** -0.5)
        log_dt = (lambda *s: torch.randn(*s, dtype=torch.bfloat16) * 0.2)(P) * 0.3 - 2.0
        Dskip = (lambda *s: torch.randn(*s, dtype=torch.bfloat16) * 0.05)(D)
        return {
            "x": _w((lambda *s: torch.randn(*s, dtype=torch.bfloat16) * 0.05)(B, S, D)),
            "Lambda_re": _w(Lambda_re),
            "Lambda_im": _w(Lambda_im),
            "B_re": _w(B_re),
            "B_im": _w(B_im),
            "C_re": _w(C_re),
            "C_im": _w(C_im),
            "log_dt": _w(log_dt),
            "Dskip": _w(Dskip),
        }
    _A_in = _A_setup()

    def _B_setup():
        B, S, D, F = 1, 2048, 512, 1792
        return {
            "x": _w((lambda *s: torch.randn(*s, dtype=torch.bfloat16) * 0.05)(B, S, D)),
            "w1": _w((lambda *s: torch.randn(*s, dtype=torch.bfloat16) * 0.8)(D, F) * (D ** -0.5)),
            "b1": _w((lambda *s: torch.randn(*s, dtype=torch.bfloat16) * 12.8)(F) * 0.01),
            "w2": _w((lambda *s: torch.randn(*s, dtype=torch.bfloat16) * 0.8)(F, D) * (F ** -0.5)),
            "b2": _w((lambda *s: torch.randn(*s, dtype=torch.bfloat16) * 12.8)(D) * 0.01),
        }
    _B_in = _B_setup()

    return {
        "A_x": _A_in["x"],
        "A_Lambda_re": _A_in["Lambda_re"],
        "A_Lambda_im": _A_in["Lambda_im"],
        "A_B_re": _A_in["B_re"],
        "A_B_im": _A_in["B_im"],
        "A_C_re": _A_in["C_re"],
        "A_C_im": _A_in["C_im"],
        "A_log_dt": _A_in["log_dt"],
        "A_Dskip": _A_in["Dskip"],
        "B_x": _B_in["x"],
        "B_w1": _B_in["w1"],
        "B_b1": _B_in["b1"],
        "B_w2": _B_in["w2"],
        "B_b2": _B_in["b2"],
    }

def reference(A_x, A_Lambda_re, A_Lambda_im, A_B_re, A_B_im, A_C_re, A_C_im, A_log_dt, A_Dskip, B_x, B_w1, B_b1, B_w2, B_b2):
    def _A_ref(x, Lambda_re, Lambda_im, B_re, B_im, C_re, C_im, log_dt, Dskip):
        Bsz, L, H = x.shape
        Lam = Lambda_re + 1j * Lambda_im
        Bmat = B_re + 1j * B_im
        Cmat = C_re + 1j * C_im
        dt = torch.exp(log_dt)
        Lam_bar = torch.exp(dt * Lam)
        B_bar = ((Lam_bar - 1.0) / Lam)[:, None] * Bmat
        Bu = torch.einsum("bld,pd->blp", x + 0j, B_bar)
        h = torch.zeros_like(Bu[:, 0, :])
        hs = []
        for t in range(L):
            h = Lam_bar[None, :] * h + Bu[:, t, :]
            hs.append(h)
        hseq = torch.stack(hs, 1)
        y = 2.0 * torch.einsum("blp,dp->bld", hseq, Cmat).real + x * Dskip[None, None, :]
        return y

    def _B_ref(x, w1, b1, w2, b2):
        h = torch.einsum("bsd,df->bsf", x, w1) + b1
        h = _gelu(h)
        return torch.einsum("bsf,fd->bsd", h, w2) + b2

    x = A_x
    xn = _layernorm(x, axis=-1)
    return x + _A_ref(xn, A_Lambda_re, A_Lambda_im, A_B_re, A_B_im, A_C_re, A_C_im, A_log_dt, A_Dskip) + _B_ref(xn, B_w1, B_b1, B_w2, B_b2)
```

```asm
; @launch grid=(256,1,1) block=(512,1,1) lds=163840
.amdgcn_target "amdgcn-amd-amdhsa--gfx950"
.text
.globl parallel_sum__ssm_conv_s5__dense_activation_gelu__prompt_kernel
.p2align 8
.type parallel_sum__ssm_conv_s5__dense_activation_gelu__prompt_kernel,@function
parallel_sum__ssm_conv_s5__dense_activation_gelu__prompt_kernel:
    s_cmp_ge_u32 s2, 256
    s_cbranch_scc1 parallel_sum__ssm_conv_s5__dense_activation_gelu__prompt_kernel_end
    s_load_dwordx2 s[4:5], s[0:1], 0
    s_load_dwordx4 s[8:11], s[0:1], 24
    s_load_dwordx4 s[16:19], s[0:1], 80
    s_load_dwordx4 s[20:23], s[0:1], 120
    s_load_dwordx4 s[12:15], s[0:1], 8
    s_load_dwordx2 s[6:7], s[0:1], 56
    v_lshrrev_b32 v1, 6, v0
    s_and_b32 s25, s2, 7
    v_readfirstlane_b32 s24, v1
    v_and_b32 v1, 63, v0
    s_lshr_b32 s26, s2, 3
    s_lshr_b32 s27, s26, 3
    s_lshr_b32 s28, s25, 1
    s_lshl_b32 s28, s28, 2
    s_add_u32 s27, s27, s28
    s_and_b32 s28, s26, 7
    s_and_b32 s53, s25, 1
    s_lshl_b32 s53, s53, 3
    s_add_u32 s28, s28, s53
    s_lshr_b32 s29, s28, 2
    s_mul_i32 s29, s29, 7
    s_and_b32 s30, s28, 3
    s_lshl_b32 s31, s30, 1
    s_add_u32 s29, s29, s31
    v_and_b32 v2, 31, v1
    v_lshrrev_b32 v3, 5, v1
    s_and_b32 s31, s24, 3
    s_lshl_b32 s52, s31, 12
    v_and_b32 v15, 7, v1
    v_lshrrev_b32 v18, 4, v1
    v_xor_b32 v15, v15, v18
    v_lshlrev_b32 v15, 4, v15
    v_lshlrev_b32 v19, 4, v3
    v_bfe_u32 v20, v1, 3, 2
    v_add_u32 v19, v19, v20
    v_lshl_add_u32 v12, v19, 10, v15
    v_xor_b32 v13, 64, v12
    v_lshrrev_b32 v18, 3, v1
    v_lshl_add_u32 v127, v18, 10, v15
    s_and_b32 s53, s24, 1
    s_lshl_b32 s53, s53, 6
    v_xor_b32 v127, s53, v127
    s_lshl_b32 s54, s27, 17
    s_lshr_b32 s53, s24, 1
    s_lshl_b32 s53, s53, 15
    s_add_u32 s54, s54, s53
    s_and_b32 s53, s24, 1
    s_lshl_b32 s53, s53, 13
    s_add_u32 s54, s54, s53
    s_lshl_b32 s55, s28, 15
    s_and_b32 s53, s24, 3
    s_lshl_b32 s53, s53, 13
    s_add_u32 s55, s55, s53
    s_lshl_b32 s58, s24, 11
    s_lshl_b32 s56, s24, 10
    s_mul_i32 s57, s24, 28672
    s_lshl_b32 s53, s29, 7
    s_add_u32 s57, s57, s53
    s_mov_b32 s25, s24
    s_cmp_ge_u32 s24, 4
    s_cbranch_scc1 parallel_sum__ssm_conv_s5__dense_activation_gelu__prompt_kernel_B
    s_waitcnt lgkmcnt(0)
    s_mov_b32 s53, 14909440
    s_load_dword s93, s[22:23], s53
    s_mov_b32 s48, s4
    s_and_b32 s49, s5, 0xffff
    s_mov_b32 s50, 2097152
    s_mov_b32 s51, 0x00020000
    s_cmp_ge_u32 s25, 4
    s_cselect_b32 s84, s10, s8
    s_cselect_b32 s85, s11, s9
    s_and_b32 s85, s85, 0xffff
    s_mov_b32 s86, 0x80000
    s_mov_b32 s87, 0x00020000
    s_add_u32 m0, s58, 0
    s_add_u32 s62, s54, 0
    buffer_load_dwordx4 v12, s[48:51], s62 offen lds
    s_add_u32 m0, s58, 1024
    s_add_u32 s62, s54, 4096
    buffer_load_dwordx4 v13, s[48:51], s62 offen lds
    s_add_u32 m0, s56, 16384
    s_add_u32 s62, s55, 0
    buffer_load_dwordx4 v127, s[84:87], s62 offen lds
    s_mov_b32 s64, s12
    s_and_b32 s65, s13, 0xffff
    s_mov_b32 s66, 1024
    s_mov_b32 s67, 0x00020000
    s_mov_b32 s68, s14
    s_and_b32 s69, s15, 0xffff
    s_mov_b32 s70, 1024
    s_mov_b32 s71, 0x00020000
    s_mov_b32 s72, s6
    s_and_b32 s73, s7, 0xffff
    s_mov_b32 s74, 1024
    s_mov_b32 s75, 0x00020000
    s_lshl_b32 s53, s28, 6
    v_lshlrev_b32 v15, 1, v2
    buffer_load_ushort v112, v15, s[64:67], s53 offen
    buffer_load_ushort v113, v15, s[68:71], s53 offen
    buffer_load_ushort v114, v15, s[72:75], s53 offen
    s_add_u32 m0, s58, 24576
    s_add_u32 s62, s54, 128
    buffer_load_dwordx4 v12, s[48:51], s62 offen lds
    s_add_u32 m0, s58, 25600
    s_add_u32 s62, s54, 4224
    buffer_load_dwordx4 v13, s[48:51], s62 offen lds
    s_add_u32 m0, s56, 40960
    s_add_u32 s62, s55, 128
    buffer_load_dwordx4 v127, s[84:87], s62 offen lds
    s_add_u32 m0, s58, 49152
    s_add_u32 s62, s54, 256
    buffer_load_dwordx4 v12, s[48:51], s62 offen lds
    s_add_u32 m0, s58, 50176
    s_add_u32 s62, s54, 4352
    buffer_load_dwordx4 v13, s[48:51], s62 offen lds
    s_add_u32 m0, s56, 65536
    s_add_u32 s62, s55, 256
    buffer_load_dwordx4 v127, s[84:87], s62 offen lds
    s_mov_b32 s44, s16
    s_and_b32 s45, s17, 0xffff
    s_mov_b32 s46, 1835008
    s_mov_b32 s47, 0x00020000
    s_movk_i32 s53, 3584
    v_lshrrev_b32 v14, 3, v1
    v_mul_lo_u32 v14, v14, s53
    v_bfe_u32 v15, v1, 4, 1
    v_lshlrev_b32 v15, 2, v15
    v_xor_b32 v15, v15, v1
    v_and_b32 v15, 7, v15
    v_lshl_add_u32 v14, v15, 4, v14
    v_bfe_u32 v15, v2, 1, 3
    v_xor_b32 v15, v15, v3
    v_lshlrev_b32 v15, 4, v15
    v_lshl_add_u32 v15, v2, 7, v15
    v_xor_b32 v8, 0, v15
    v_add_u32 v4, s52, v8
    v_add_u32 v8, 16384, v8
    v_xor_b32 v9, 32, v15
    v_add_u32 v5, s52, v9
    v_add_u32 v9, 16384, v9
    v_xor_b32 v10, 64, v15
    v_add_u32 v6, s52, v10
    v_add_u32 v10, 16384, v10
    v_xor_b32 v11, 96, v15
    v_add_u32 v7, s52, v11
    v_add_u32 v11, 16384, v11
    s_mov_b32 s32, s22
    s_and_b32 s33, s23, 0xffff
    s_mov_b32 s34, 14911744
    s_mov_b32 s35, 0x00020000
    s_mov_b32 s36, s20
    s_and_b32 s37, s21, 0xffff
    s_mov_b32 s38, 256
    s_mov_b32 s39, 0x00020000
    s_mov_b32 s40, s18
    s_and_b32 s41, s19, 0xffff
    s_mov_b32 s42, 3584
    s_mov_b32 s43, 0x00020000
    s_waitcnt lgkmcnt(0)
    s_add_u32 s93, s93, 1
    s_waitcnt vmcnt(9) lgkmcnt(0)
    s_barrier
    ds_read_b128 a[0:3], v4
    ds_read_b128 v[48:51], v8
    ds_read_b128 v[52:55], v8 offset:4096
    ds_read_b128 a[4:7], v5
    ds_read_b128 v[56:59], v9
    ds_read_b128 v[60:63], v9 offset:4096
    ds_read_b128 a[8:11], v6
    ds_read_b128 v[64:67], v10
    ds_read_b128 v[68:71], v10 offset:4096
    ds_read_b128 a[12:15], v7
    ds_read_b128 v[72:75], v11
    ds_read_b128 v[76:79], v11 offset:4096
    v_add_u32 v4, 24576, v4
    v_add_u32 v5, 24576, v5
    v_add_u32 v6, 24576, v6
    v_add_u32 v7, 24576, v7
    v_add_u32 v8, 24576, v8
    v_add_u32 v9, 24576, v9
    v_add_u32 v10, 24576, v10
    v_add_u32 v11, 24576, v11
    s_add_u32 m0, s58, 73728
    s_add_u32 s62, s54, 384
    buffer_load_dwordx4 v12, s[48:51], s62 offen lds
    s_add_u32 m0, s58, 74752
    s_add_u32 s62, s54, 4480
    buffer_load_dwordx4 v13, s[48:51], s62 offen lds
    s_add_u32 m0, s56, 90112
    s_add_u32 s62, s55, 384
    buffer_load_dwordx4 v127, s[84:87], s62 offen lds
    s_waitcnt vmcnt(6) lgkmcnt(0)
    s_barrier
    v_mfma_f32_32x32x16_bf16 v[16:31], a[0:3], v[48:51], 0
    ds_read_b128 a[16:19], v4
    ds_read_b128 v[80:83], v8
    ds_read_b128 v[84:87], v8 offset:4096
    v_mfma_f32_32x32x16_bf16 v[32:47], a[0:3], v[52:55], 0
    ds_read_b128 a[20:23], v5
    ds_read_b128 v[88:91], v9
    ds_read_b128 v[92:95], v9 offset:4096
    v_mfma_f32_32x32x16_bf16 v[16:31], a[4:7], v[56:59], v[16:31]
    ds_read_b128 a[24:27], v6
    ds_read_b128 v[96:99], v10
    ds_read_b128 v[100:103], v10 offset:4096
    v_mfma_f32_32x32x16_bf16 v[32:47], a[4:7], v[60:63], v[32:47]
    ds_read_b128 a[28:31], v7
    ds_read_b128 v[104:107], v11
    ds_read_b128 v[108:111], v11 offset:4096
    v_add_u32 v4, 24576, v4
    v_add_u32 v5, 24576, v5
    v_add_u32 v6, 24576, v6
    v_add_u32 v7, 24576, v7
    v_add_u32 v8, 24576, v8
    v_add_u32 v9, 24576, v9
    v_add_u32 v10, 24576, v10
    v_add_u32 v11, 24576, v11
    v_mfma_f32_32x32x16_bf16 v[16:31], a[8:11], v[64:67], v[16:31]
    s_add_u32 m0, s58, 98304
    s_add_u32 s62, s54, 512
    buffer_load_dwordx4 v12, s[48:51], s62 offen lds
    v_mfma_f32_32x32x16_bf16 v[32:47], a[8:11], v[68:71], v[32:47]
    s_add_u32 m0, s58, 99328
    s_add_u32 s62, s54, 4608
    buffer_load_dwordx4 v13, s[48:51], s62 offen lds
    v_mfma_f32_32x32x16_bf16 v[16:31], a[12:15], v[72:75], v[16:31]
    s_add_u32 m0, s56, 114688
    s_add_u32 s62, s55, 512
    buffer_load_dwordx4 v127, s[84:87], s62 offen lds
    v_mfma_f32_32x32x16_bf16 v[32:47], a[12:15], v[76:79], v[32:47]
    s_waitcnt vmcnt(6) lgkmcnt(0)
    s_barrier
    v_mfma_f32_32x32x16_bf16 v[16:31], a[16:19], v[80:83], v[16:31]
    ds_read_b128 a[32:35], v4
    ds_read_b128 v[48:51], v8
    ds_read_b128 v[52:55], v8 offset:4096
    v_mfma_f32_32x32x16_bf16 v[32:47], a[16:19], v[84:87], v[32:47]
    ds_read_b128 a[36:39], v5
    ds_read_b128 v[56:59], v9
    ds_read_b128 v[60:63], v9 offset:4096
    v_mfma_f32_32x32x16_bf16 v[16:31], a[20:23], v[88:91], v[16:31]
    ds_read_b128 a[40:43], v6
    ds_read_b128 v[64:67], v10
    ds_read_b128 v[68:71], v10 offset:4096
    v_mfma_f32_32x32x16_bf16 v[32:47], a[20:23], v[92:95], v[32:47]
    ds_read_b128 a[44:47], v7
    ds_read_b128 v[72:75], v11
    ds_read_b128 v[76:79], v11 offset:4096
    v_add_u32 v4, 24576, v4
    v_add_u32 v5, 24576, v5
    v_add_u32 v6, 24576, v6
    v_add_u32 v7, 24576, v7
    v_add_u32 v8, 24576, v8
    v_add_u32 v9, 24576, v9
    v_add_u32 v10, 24576, v10
    v_add_u32 v11, 24576, v11
    v_mfma_f32_32x32x16_bf16 v[16:31], a[24:27], v[96:99], v[16:31]
    s_add_u32 m0, s58, 122880
    s_add_u32 s62, s54, 640
    buffer_load_dwordx4 v12, s[48:51], s62 offen lds
    v_mfma_f32_32x32x16_bf16 v[32:47], a[24:27], v[100:103], v[32:47]
    s_add_u32 m0, s58, 123904
    s_add_u32 s62, s54, 4736
    buffer_load_dwordx4 v13, s[48:51], s62 offen lds
    v_mfma_f32_32x32x16_bf16 v[16:31], a[28:31], v[104:107], v[16:31]
    s_add_u32 m0, s56, 139264
    s_add_u32 s62, s55, 640
    buffer_load_dwordx4 v127, s[84:87], s62 offen lds
    v_mfma_f32_32x32x16_bf16 v[32:47], a[28:31], v[108:111], v[32:47]
    s_waitcnt vmcnt(6) lgkmcnt(0)
    s_barrier
    v_mfma_f32_32x32x16_bf16 v[16:31], a[32:35], v[48:51], v[16:31]
    ds_read_b128 a[48:51], v4
    ds_read_b128 v[80:83], v8
    ds_read_b128 v[84:87], v8 offset:4096
    v_mfma_f32_32x32x16_bf16 v[32:47], a[32:35], v[52:55], v[32:47]
    ds_read_b128 a[52:55], v5
    ds_read_b128 v[88:91], v9
    ds_read_b128 v[92:95], v9 offset:4096
    v_mfma_f32_32x32x16_bf16 v[16:31], a[36:39], v[56:59], v[16:31]
    ds_read_b128 a[56:59], v6
    ds_read_b128 v[96:99], v10
    ds_read_b128 v[100:103], v10 offset:4096
    v_mfma_f32_32x32x16_bf16 v[32:47], a[36:39], v[60:63], v[32:47]
    ds_read_b128 a[60:63], v7
    ds_read_b128 v[104:107], v11
    ds_read_b128 v[108:111], v11 offset:4096
    v_add_u32 v4, 24576, v4
    v_add_u32 v5, 24576, v5
    v_add_u32 v6, 24576, v6
    v_add_u32 v7, 24576, v7
    v_add_u32 v8, 24576, v8
    v_add_u32 v9, 24576, v9
    v_add_u32 v10, 24576, v10
    v_add_u32 v11, 24576, v11
    v_mfma_f32_32x32x16_bf16 v[16:31], a[40:43], v[64:67], v[16:31]
    s_add_u32 m0, s58, 0
    s_add_u32 s62, s54, 768
    buffer_load_dwordx4 v12, s[48:51], s62 offen lds
    v_mfma_f32_32x32x16_bf16 v[32:47], a[40:43], v[68:71], v[32:47]
    s_add_u32 m0, s58, 1024
    s_add_u32 s62, s54, 4864
    buffer_load_dwordx4 v13, s[48:51], s62 offen lds
    v_mfma_f32_32x32x16_bf16 v[16:31], a[44:47], v[72:75], v[16:31]
    s_add_u32 m0, s56, 16384
    s_add_u32 s62, s55, 768
    buffer_load_dwordx4 v127, s[84:87], s62 offen lds
    v_mfma_f32_32x32x16_bf16 v[32:47], a[44:47], v[76:79], v[32:47]
    s_waitcnt vmcnt(6) lgkmcnt(0)
    s_barrier
    v_mfma_f32_32x32x16_bf16 v[16:31], a[48:51], v[80:83], v[16:31]
    ds_read_b128 a[64:67], v4
    ds_read_b128 v[48:51], v8
    ds_read_b128 v[52:55], v8 offset:4096
    v_mfma_f32_32x32x16_bf16 v[32:47], a[48:51], v[84:87], v[32:47]
    ds_read_b128 a[68:71], v5
    ds_read_b128 v[56:59], v9
    ds_read_b128 v[60:63], v9 offset:4096
    v_mfma_f32_32x32x16_bf16 v[16:31], a[52:55], v[88:91], v[16:31]
    ds_read_b128 a[72:75], v6
    ds_read_b128 v[64:67], v10
    ds_read_b128 v[68:71], v10 offset:4096
    v_mfma_f32_32x32x16_bf16 v[32:47], a[52:55], v[92:95], v[32:47]
    ds_read_b128 a[76:79], v7
    ds_read_b128 v[72:75], v11
    ds_read_b128 v[76:79], v11 offset:4096
    v_add_u32 v4, 24576, v4
    v_add_u32 v5, 24576, v5
    v_add_u32 v6, 24576, v6
    v_add_u32 v7, 24576, v7
    v_add_u32 v8, 24576, v8
    v_add_u32 v9, 24576, v9
    v_add_u32 v10, 24576, v10
    v_add_u32 v11, 24576, v11
    v_mfma_f32_32x32x16_bf16 v[16:31], a[56:59], v[96:99], v[16:31]
    s_add_u32 m0, s58, 24576
    s_add_u32 s62, s54, 896
    buffer_load_dwordx4 v12, s[48:51], s62 offen lds
    v_mfma_f32_32x32x16_bf16 v[32:47], a[56:59], v[100:103], v[32:47]
    s_add_u32 m0, s58, 25600
    s_add_u32 s62, s54, 4992
    buffer_load_dwordx4 v13, s[48:51], s62 offen lds
    v_mfma_f32_32x32x16_bf16 v[16:31], a[60:63], v[104:107], v[16:31]
    s_add_u32 m0, s56, 40960
    s_add_u32 s62, s55, 896
    buffer_load_dwordx4 v127, s[84:87], s62 offen lds
    v_mfma_f32_32x32x16_bf16 v[32:47], a[60:63], v[108:111], v[32:47]
    s_waitcnt vmcnt(6) lgkmcnt(0)
    s_barrier
    v_mfma_f32_32x32x16_bf16 v[16:31], a[64:67], v[48:51], v[16:31]
    ds_read_b128 a[80:83], v4
    ds_read_b128 v[80:83], v8
    ds_read_b128 v[84:87], v8 offset:4096
    v_mfma_f32_32x32x16_bf16 v[32:47], a[64:67], v[52:55], v[32:47]
    ds_read_b128 a[84:87], v5
    ds_read_b128 v[88:91], v9
    ds_read_b128 v[92:95], v9 offset:4096
    v_mfma_f32_32x32x16_bf16 v[16:31], a[68:71], v[56:59], v[16:31]
    ds_read_b128 a[88:91], v6
    ds_read_b128 v[96:99], v10
    ds_read_b128 v[100:103], v10 offset:4096
    v_mfma_f32_32x32x16_bf16 v[32:47], a[68:71], v[60:63], v[32:47]
    ds_read_b128 a[92:95], v7
    ds_read_b128 v[104:107], v11
    ds_read_b128 v[108:111], v11 offset:4096
    v_subrev_u32 v4, 122880, v4
    v_subrev_u32 v5, 122880, v5
    v_subrev_u32 v6, 122880, v6
    v_subrev_u32 v7, 122880, v7
    v_subrev_u32 v8, 122880, v8
    v_subrev_u32 v9, 122880, v9
    v_subrev_u32 v10, 122880, v10
    v_subrev_u32 v11, 122880, v11
    v_mfma_f32_32x32x16_bf16 v[16:31], a[72:75], v[64:67], v[16:31]
    s_add_u32 m0, s56, 49152
    s_add_u32 s62, s57, 0
    buffer_load_dwordx4 v14, s[44:47], s62 offen lds
    v_mfma_f32_32x32x16_bf16 v[32:47], a[72:75], v[68:71], v[32:47]
    s_add_u32 m0, s56, 57344
    s_add_u32 s62, s57, 229376
    buffer_load_dwordx4 v14, s[44:47], s62 offen lds
    v_mfma_f32_32x32x16_bf16 v[16:31], a[76:79], v[72:75], v[16:31]
    s_add_u32 m0, s56, 65536
    s_add_u32 s62, s57, 458752
    buffer_load_dwordx4 v14, s[44:47], s62 offen lds
    v_mfma_f32_32x32x16_bf16 v[32:47], a[76:79], v[76:79], v[32:47]
    v_lshlrev_b32 v112, 16, v112
    v_lshlrev_b32 v113, 16, v113
    v_lshlrev_b32 v114, 16, v114
    v_mul_f32 v114, 0x3fb8aa3b, v114
    v_exp_f32 v114, v114
    s_nop 0
    v_cvt_pk_bf16_f32 v114, v114, v114
    v_and_b32 v114, 0xffff0000, v114
    v_mul_f32 v115, v114, v112
    v_mul_f32 v127, v114, v113
    v_mul_f32 v115, 0x3fb8aa3b, v115
    v_mul_f32 v127, 0x3e22f983, v127
    v_mul_f32 v15, 1.0, v115
    v_mul_f32 v117, 1.0, v127
    v_exp_f32 v15, v15
    v_fract_f32 v117, v117
    v_cos_f32 v116, v117
    v_sin_f32 v117, v117
    v_mul_f32 v116, v116, v15
    v_mul_f32 v117, v117, v15
    v_mul_f32 v15, 0x41800000, v115
    v_mul_f32 v119, 0x41800000, v127
    v_exp_f32 v15, v15
    v_fract_f32 v119, v119
    v_cos_f32 v118, v119
    v_sin_f32 v119, v119
    v_mul_f32 v118, v118, v15
    v_mul_f32 v119, v119, v15
    v_mul_f32 v15, 0x43000000, v115
    v_mul_f32 v121, 0x43000000, v127
    v_exp_f32 v15, v15
    v_fract_f32 v121, v121
    v_cos_f32 v120, v121
    v_sin_f32 v121, v121
    v_mul_f32 v120, v120, v15
    v_mul_f32 v121, v121, v15
    s_lshl_b32 s54, s31, 1
    v_add_u32 v114, s54, v3
    v_cvt_f32_u32 v114, v114
    v_mul_f32 v114, 0x41800000, v114
    v_mul_f32 v15, v114, v115
    v_mul_f32 v123, v114, v127
    v_exp_f32 v15, v15
    v_fract_f32 v123, v123
    v_cos_f32 v122, v123
    v_sin_f32 v123, v123
    v_mul_f32 v122, v122, v15
    v_mul_f32 v123, v123, v15
    v_add_f32 v114, -1.0, v116
    v_mul_f32 v15, v112, v112
    v_fmac_f32 v15, v113, v113
    v_rcp_f32 v15, v15
    s_nop 0
    v_add_f32 v15, v15, v15
    v_mul_f32 v124, v114, v112
    v_fmac_f32 v124, v117, v113
    v_mul_f32 v125, v117, v112
    v_fma_f32 v125, -v114, v113, v125
    v_mul_f32 v124, v124, v15
    v_mul_f32 v125, v125, v15
    s_waitcnt vmcnt(6) lgkmcnt(0)
    s_barrier
    v_mfma_f32_32x32x16_bf16 v[16:31], a[80:83], v[80:83], v[16:31]
    ds_read_b128 a[96:99], v4
    ds_read_b128 v[48:51], v8
    ds_read_b128 v[52:55], v8 offset:4096
    v_mfma_f32_32x32x16_bf16 v[32:47], a[80:83], v[84:87], v[32:47]
    ds_read_b128 a[100:103], v5
    ds_read_b128 v[56:59], v9
    ds_read_b128 v[60:63], v9 offset:4096
    v_mfma_f32_32x32x16_bf16 v[16:31], a[84:87], v[88:91], v[16:31]
    ds_read_b128 a[104:107], v6
    ds_read_b128 v[64:67], v10
    ds_read_b128 v[68:71], v10 offset:4096
    v_mfma_f32_32x32x16_bf16 v[32:47], a[84:87], v[92:95], v[32:47]
    ds_read_b128 a[108:111], v7
    ds_read_b128 v[72:75], v11
    ds_read_b128 v[76:79], v11 offset:4096
    v_add_u32 v4, 24576, v4
    v_add_u32 v5, 24576, v5
    v_add_u32 v6, 24576, v6
    v_add_u32 v7, 24576, v7
    v_add_u32 v8, 24576, v8
    v_add_u32 v9, 24576, v9
    v_add_u32 v10, 24576, v10
    v_add_u32 v11, 24576, v11
    v_mfma_f32_32x32x16_bf16 v[16:31], a[88:91], v[96:99], v[16:31]
    s_add_u32 m0, s56, 73728
    s_add_u32 s62, s57, 688128
    buffer_load_dwordx4 v14, s[44:47], s62 offen lds
    v_mfma_f32_32x32x16_bf16 v[32:47], a[88:91], v[100:103], v[32:47]
    s_add_u32 m0, s56, 81920
    s_add_u32 s62, s57, 917504
    buffer_load_dwordx4 v14, s[44:47], s62 offen lds
    v_mfma_f32_32x32x16_bf16 v[16:31], a[92:95], v[104:107], v[16:31]
    s_add_u32 m0, s56, 90112
    s_add_u32 s62, s57, 1146880
    buffer_load_dwordx4 v14, s[44:47], s62 offen lds
    v_mfma_f32_32x32x16_bf16 v[32:47], a[92:95], v[108:111], v[32:47]
    s_waitcnt vmcnt(6) lgkmcnt(0)
    s_barrier
    v_mfma_f32_32x32x16_bf16 v[16:31], a[96:99], v[48:51], v[16:31]
    ds_read_b128 a[112:115], v4
    ds_read_b128 v[80:83], v8
    ds_read_b128 v[84:87], v8 offset:4096
    v_mfma_f32_32x32x16_bf16 v[32:47], a[96:99], v[52:55], v[32:47]
    ds_read_b128 a[116:119], v5
    ds_read_b128 v[88:91], v9
    ds_read_b128 v[92:95], v9 offset:4096
    v_mfma_f32_32x32x16_bf16 v[16:31], a[100:103], v[56:59], v[16:31]
    ds_read_b128 a[120:123], v6
    ds_read_b128 v[96:99], v10
    ds_read_b128 v[100:103], v10 offset:4096
    v_mfma_f32_32x32x16_bf16 v[32:47], a[100:103], v[60:63], v[32:47]
    ds_read_b128 a[124:127], v7
    ds_read_b128 v[104:107], v11
    ds_read_b128 v[108:111], v11 offset:4096
    v_mfma_f32_32x32x16_bf16 v[16:31], a[104:107], v[64:67], v[16:31]
    s_add_u32 m0, s56, 98304
    s_add_u32 s62, s57, 1376256
    buffer_load_dwordx4 v14, s[44:47], s62 offen lds
    v_mfma_f32_32x32x16_bf16 v[32:47], a[104:107], v[68:71], v[32:47]
    s_add_u32 m0, s56, 106496
    s_add_u32 s62, s57, 1605632
    buffer_load_dwordx4 v14, s[44:47], s62 offen lds
    v_mfma_f32_32x32x16_bf16 v[16:31], a[108:111], v[72:75], v[16:31]
    v_mfma_f32_32x32x16_bf16 v[32:47], a[108:111], v[76:79], v[32:47]
    s_waitcnt lgkmcnt(10)
    v_mfma_f32_32x32x16_bf16 v[16:31], a[112:115], v[80:83], v[16:31]
    s_waitcnt lgkmcnt(9)
    v_mfma_f32_32x32x16_bf16 v[32:47], a[112:115], v[84:87], v[32:47]
    s_waitcnt lgkmcnt(7)
    v_mfma_f32_32x32x16_bf16 v[16:31], a[116:119], v[88:91], v[16:31]
    s_waitcnt lgkmcnt(6)
    v_mfma_f32_32x32x16_bf16 v[32:47], a[116:119], v[92:95], v[32:47]
    s_waitcnt lgkmcnt(4)
    v_mfma_f32_32x32x16_bf16 v[16:31], a[120:123], v[96:99], v[16:31]
    s_waitcnt lgkmcnt(3)
    v_mfma_f32_32x32x16_bf16 v[32:47], a[120:123], v[100:103], v[32:47]
    s_waitcnt lgkmcnt(1)
    v_mfma_f32_32x32x16_bf16 v[16:31], a[124:127], v[104:107], v[16:31]
    s_waitcnt lgkmcnt(0)
    v_mfma_f32_32x32x16_bf16 v[32:47], a[124:127], v[108:111], v[32:47]
    s_waitcnt vmcnt(0) lgkmcnt(0)
    s_barrier
    s_setprio 3
    v_and_b32 v12, 3, v1
    v_lshlrev_b32 v12, 8, v12
    v_add_u32 v12, 21760, v12
    v_mov_b32 v64, 0
    v_mov_b32 v65, 0
    ds_write_b64 v12, v[64:65]
    s_nop 1
    v_mov_b32 v12, 21504
    ds_write_b32 v12, v64
    s_lshl_b32 s54, s31, 8
    s_add_u32 s54, s54, 16384
    v_lshlrev_b32 v12, 3, v2
    v_add_u32 v12, s54, v12
    ds_read_b32 v48, v12
    v_lshlrev_b32 v13, 2, v2
    v_add_u32 v13, 17920, v13
    ds_read_b32 v49, v13
    ds_read_b32 v50, v13 offset:128
    s_lshl_b32 s54, s31, 7
    s_add_u32 s54, s54, 17408
    v_lshlrev_b32 v15, 6, v3
    v_add_u32 v15, s54, v15
    ds_read_b128 v[80:83], v15 offset:0
    ds_read_b128 v[84:87], v15 offset:16
    ds_read_b128 v[88:91], v15 offset:32
    ds_read_b128 v[92:95], v15 offset:48
    v_mov_b32 v52, 0
    v_mov_b32 v53, 0
    v_mov_b32 v54, 0
    v_mov_b32 v55, 0
    v_mov_b32 v56, 0
    v_mov_b32 v57, 0
    v_mov_b32 v58, 0
    v_mov_b32 v59, 0
    v_mov_b32 v60, 0
    v_mov_b32 v61, 0
    v_mov_b32 v62, 0
    v_mov_b32 v63, 0
    s_waitcnt lgkmcnt(4)
    v_cvt_pk_bf16_f32 v51, v49, v50
    v_lshlrev_b32 v64, 16, v51
    v_and_b32 v65, 0xffff0000, v51
    v_sub_f32 v64, v49, v64
    v_sub_f32 v65, v50, v65
    s_mov_b32 exec_hi, 0
    v_cvt_pk_bf16_f32 v52, -v48, -v48
    v_cvt_pk_bf16_f32 v56, v49, v64
    v_cvt_pk_bf16_f32 v60, v50, v65
    s_mov_b32 exec_hi, -1
    v_mfma_f32_32x32x16_bf16 v[16:31], v[52:55], v[56:59], v[16:31]
    v_mfma_f32_32x32x16_bf16 v[32:47], v[52:55], v[60:63], v[32:47]
    s_waitcnt lgkmcnt(3)
    s_nop 9
    v_mul_f32 v48, v16, v80
    v_mul_f32 v49, v32, v80
    v_mul_f32 v50, v17, v81
    v_mul_f32 v51, v33, v81
    v_mul_f32 v52, v18, v82
    v_mul_f32 v53, v34, v82
    v_mul_f32 v54, v19, v83
    v_mul_f32 v55, v35, v83
    s_waitcnt lgkmcnt(2)
    v_mul_f32 v56, v20, v84
    v_mul_f32 v57, v36, v84
    v_mul_f32 v58, v21, v85
    v_mul_f32 v59, v37, v85
    v_mul_f32 v60, v22, v86
    v_mul_f32 v61, v38, v86
    v_mul_f32 v62, v23, v87
    v_mul_f32 v63, v39, v87
    s_waitcnt lgkmcnt(1)
    v_mul_f32 v64, v24, v88
    v_mul_f32 v65, v40, v88
    v_mul_f32 v66, v25, v89
    v_mul_f32 v67, v41, v89
    v_mul_f32 v68, v26, v90
    v_mul_f32 v69, v42, v90
    v_mul_f32 v70, v27, v91
    v_mul_f32 v71, v43, v91
    s_waitcnt lgkmcnt(0)
    v_mul_f32 v72, v28, v92
    v_mul_f32 v73, v44, v92
    v_mul_f32 v74, v29, v93
    v_mul_f32 v75, v45, v93
    v_mul_f32 v76, v30, v94
    v_mul_f32 v77, v46, v94
    v_mul_f32 v78, v31, v95
    v_mul_f32 v79, v47, v95
    v_pk_fma_f32 v[98:99], v[116:117], v[48:49], v[50:51] op_sel:[0,0,0] op_sel_hi:[0,1,1]
    v_pk_fma_f32 v[96:97], v[116:117], v[48:49], v[98:99] op_sel:[1,1,0] op_sel_hi:[1,0,1] neg_lo:[1,0,0]
    v_pk_fma_f32 v[98:99], v[116:117], v[96:97], v[52:53] op_sel:[0,0,0] op_sel_hi:[0,1,1]
    v_pk_fma_f32 v[96:97], v[116:117], v[96:97], v[98:99] op_sel:[1,1,0] op_sel_hi:[1,0,1] neg_lo:[1,0,0]
    v_pk_fma_f32 v[98:99], v[116:117], v[96:97], v[54:55] op_sel:[0,0,0] op_sel_hi:[0,1,1]
    v_pk_fma_f32 v[96:97], v[116:117], v[96:97], v[98:99] op_sel:[1,1,0] op_sel_hi:[1,0,1] neg_lo:[1,0,0]
    v_pk_fma_f32 v[98:99], v[116:117], v[96:97], v[56:57] op_sel:[0,0,0] op_sel_hi:[0,1,1]
    v_pk_fma_f32 v[96:97], v[116:117], v[96:97], v[98:99] op_sel:[1,1,0] op_sel_hi:[1,0,1] neg_lo:[1,0,0]
    v_pk_fma_f32 v[98:99], v[116:117], v[96:97], v[58:59] op_sel:[0,0,0] op_sel_hi:[0,1,1]
    v_pk_fma_f32 v[96:97], v[116:117], v[96:97], v[98:99] op_sel:[1,1,0] op_sel_hi:[1,0,1] neg_lo:[1,0,0]
    v_pk_fma_f32 v[98:99], v[116:117], v[96:97], v[60:61] op_sel:[0,0,0] op_sel_hi:[0,1,1]
    v_pk_fma_f32 v[96:97], v[116:117], v[96:97], v[98:99] op_sel:[1,1,0] op_sel_hi:[1,0,1] neg_lo:[1,0,0]
    v_pk_fma_f32 v[98:99], v[116:117], v[96:97], v[62:63] op_sel:[0,0,0] op_sel_hi:[0,1,1]
    v_pk_fma_f32 v[96:97], v[116:117], v[96:97], v[98:99] op_sel:[1,1,0] op_sel_hi:[1,0,1] neg_lo:[1,0,0]
    v_pk_fma_f32 v[98:99], v[116:117], v[96:97], v[64:65] op_sel:[0,0,0] op_sel_hi:[0,1,1]
    v_pk_fma_f32 v[96:97], v[116:117], v[96:97], v[98:99] op_sel:[1,1,0] op_sel_hi:[1,0,1] neg_lo:[1,0,0]
    v_pk_fma_f32 v[98:99], v[116:117], v[96:97], v[66:67] op_sel:[0,0,0] op_sel_hi:[0,1,1]
    v_pk_fma_f32 v[96:97], v[116:117], v[96:97], v[98:99] op_sel:[1,1,0] op_sel_hi:[1,0,1] neg_lo:[1,0,0]
    v_pk_fma_f32 v[98:99], v[116:117], v[96:97], v[68:69] op_sel:[0,0,0] op_sel_hi:[0,1,1]
    v_pk_fma_f32 v[96:97], v[116:117], v[96:97], v[98:99] op_sel:[1,1,0] op_sel_hi:[1,0,1] neg_lo:[1,0,0]
    v_pk_fma_f32 v[98:99], v[116:117], v[96:97], v[70:71] op_sel:[0,0,0] op_sel_hi:[0,1,1]
    v_pk_fma_f32 v[96:97], v[116:117], v[96:97], v[98:99] op_sel:[1,1,0] op_sel_hi:[1,0,1] neg_lo:[1,0,0]
    v_pk_fma_f32 v[98:99], v[116:117], v[96:97], v[72:73] op_sel:[0,0,0] op_sel_hi:[0,1,1]
    v_pk_fma_f32 v[96:97], v[116:117], v[96:97], v[98:99] op_sel:[1,1,0] op_sel_hi:[1,0,1] neg_lo:[1,0,0]
    v_pk_fma_f32 v[98:99], v[116:117], v[96:97], v[74:75] op_sel:[0,0,0] op_sel_hi:[0,1,1]
    v_pk_fma_f32 v[96:97], v[116:117], v[96:97], v[98:99] op_sel:[1,1,0] op_sel_hi:[1,0,1] neg_lo:[1,0,0]
    v_pk_fma_f32 v[98:99], v[116:117], v[96:97], v[76:77] op_sel:[0,0,0] op_sel_hi:[0,1,1]
    v_pk_fma_f32 v[96:97], v[116:117], v[96:97], v[98:99] op_sel:[1,1,0] op_sel_hi:[1,0,1] neg_lo:[1,0,0]
    v_pk_fma_f32 v[98:99], v[116:117], v[96:97], v[78:79] op_sel:[0,0,0] op_sel_hi:[0,1,1]
    v_pk_fma_f32 v[96:97], v[116:117], v[96:97], v[98:99] op_sel:[1,1,0] op_sel_hi:[1,0,1] neg_lo:[1,0,0]
    s_lshl_b32 s54, s31, 1
    v_add_u32 v100, s54, v3
    v_lshlrev_b32 v13, 8, v100
    v_lshl_add_u32 v13, v2, 3, v13
    v_add_u32 v13, 18432, v13
    ds_write_b64 v13, v[96:97]
    s_waitcnt lgkmcnt(0)
    s_barrier
    v_lshlrev_b32 v13, 3, v2
    v_add_u32 v13, 18432, v13
    ds_read_b64 v[80:81], v13 offset:0
    ds_read_b64 v[82:83], v13 offset:256
    ds_read_b64 v[84:85], v13 offset:512
    ds_read_b64 v[86:87], v13 offset:768
    ds_read_b64 v[88:89], v13 offset:1024
    ds_read_b64 v[90:91], v13 offset:1280
    ds_read_b64 v[92:93], v13 offset:1536
    ds_read_b64 v[94:95], v13 offset:1792
    v_cmp_eq_u32 s[64:65], 1, v100
    v_cmp_eq_u32 s[66:67], 2, v100
    v_cmp_eq_u32 s[68:69], 3, v100
    v_cmp_eq_u32 s[70:71], 4, v100
    v_cmp_eq_u32 s[72:73], 5, v100
    v_cmp_eq_u32 s[74:75], 6, v100
    v_cmp_eq_u32 s[76:77], 7, v100
    v_mov_b32 v112, 0
    v_mov_b32 v113, 0
    s_waitcnt lgkmcnt(7)
    v_cndmask_b32 v112, v112, v80, s[64:65]
    v_cndmask_b32 v113, v113, v81, s[64:65]
    s_waitcnt lgkmcnt(6)
    v_pk_fma_f32 v[98:99], v[118:119], v[80:81], v[82:83] op_sel:[0,0,0] op_sel_hi:[0,1,1]
    v_pk_fma_f32 v[96:97], v[118:119], v[80:81], v[98:99] op_sel:[1,1,0] op_sel_hi:[1,0,1] neg_lo:[1,0,0]
    v_cndmask_b32 v112, v112, v96, s[66:67]
    v_cndmask_b32 v113, v113, v97, s[66:67]
    s_waitcnt lgkmcnt(5)
    v_pk_fma_f32 v[98:99], v[118:119], v[96:97], v[84:85] op_sel:[0,0,0] op_sel_hi:[0,1,1]
    v_pk_fma_f32 v[96:97], v[118:119], v[96:97], v[98:99] op_sel:[1,1,0] op_sel_hi:[1,0,1] neg_lo:[1,0,0]
    v_cndmask_b32 v112, v112, v96, s[68:69]
    v_cndmask_b32 v113, v113, v97, s[68:69]
    s_waitcnt lgkmcnt(4)
    v_pk_fma_f32 v[98:99], v[118:119], v[96:97], v[86:87] op_sel:[0,0,0] op_sel_hi:[0,1,1]
    v_pk_fma_f32 v[96:97], v[118:119], v[96:97], v[98:99] op_sel:[1,1,0] op_sel_hi:[1,0,1] neg_lo:[1,0,0]
    v_cndmask_b32 v112, v112, v96, s[70:71]
    v_cndmask_b32 v113, v113, v97, s[70:71]
    s_waitcnt lgkmcnt(3)
    v_pk_fma_f32 v[98:99], v[118:119], v[96:97], v[88:89] op_sel:[0,0,0] op_sel_hi:[0,1,1]
    v_pk_fma_f32 v[96:97], v[118:119], v[96:97], v[98:99] op_sel:[1,1,0] op_sel_hi:[1,0,1] neg_lo:[1,0,0]
    v_cndmask_b32 v112, v112, v96, s[72:73]
    v_cndmask_b32 v113, v113, v97, s[72:73]
    s_waitcnt lgkmcnt(2)
    v_pk_fma_f32 v[98:99], v[118:119], v[96:97], v[90:91] op_sel:[0,0,0] op_sel_hi:[0,1,1]
    v_pk_fma_f32 v[96:97], v[118:119], v[96:97], v[98:99] op_sel:[1,1,0] op_sel_hi:[1,0,1] neg_lo:[1,0,0]
    v_cndmask_b32 v112, v112, v96, s[74:75]
    v_cndmask_b32 v113, v113, v97, s[74:75]
    s_waitcnt lgkmcnt(1)
    v_pk_fma_f32 v[98:99], v[118:119], v[96:97], v[92:93] op_sel:[0,0,0] op_sel_hi:[0,1,1]
    v_pk_fma_f32 v[96:97], v[118:119], v[96:97], v[98:99] op_sel:[1,1,0] op_sel_hi:[1,0,1] neg_lo:[1,0,0]
    v_cndmask_b32 v112, v112, v96, s[76:77]
    v_cndmask_b32 v113, v113, v97, s[76:77]
    s_waitcnt lgkmcnt(0)
    v_pk_fma_f32 v[98:99], v[118:119], v[96:97], v[94:95] op_sel:[0,0,0] op_sel_hi:[0,1,1]
    v_pk_fma_f32 v[96:97], v[118:119], v[96:97], v[98:99] op_sel:[1,1,0] op_sel_hi:[1,0,1] neg_lo:[1,0,0]
    s_cmp_lg_u32 s24, 0
    s_cbranch_scc1 parallel_sum__ssm_conv_s5__dense_activation_gelu__prompt_kernel_nopub
    s_lshl_b32 s54, s27, 4
    s_add_u32 s54, s54, s28
    s_lshl_b32 s54, s54, 9
    s_add_u32 s54, s54, 14778368
    v_lshlrev_b32 v13, 4, v2
    v_mov_b32 v84, v96
    v_mov_b32 v85, s93
    v_mov_b32 v86, v97
    v_mov_b32 v87, s93
    s_mov_b32 exec_hi, 0
    buffer_store_dwordx4 v[84:87], v13, s[32:35], s54 offen sc1
    s_mov_b32 exec_hi, -1
parallel_sum__ssm_conv_s5__dense_activation_gelu__prompt_kernel_nopub:
    s_setprio 0
    s_lshl_b32 s54, s31, 8
    s_add_u32 s54, s54, 16384
    v_lshlrev_b32 v12, 3, v2
    v_add_u32 v12, s54, v12
    ds_read_b64 v[110:111], v12
    v_bfe_u32 v13, v1, 2, 2
    v_lshl_add_u32 v14, v3, 3, v13
    v_lshlrev_b32 v14, 7, v14
    v_bfe_u32 v15, v1, 4, 1
    v_lshlrev_b32 v15, 1, v15
    v_bfe_u32 v12, v1, 1, 1
    v_add_u32 v15, v15, v12
    v_lshrrev_b32 v12, 1, v13
    v_lshl_add_u32 v15, v12, 2, v15
    v_lshl_add_u32 v14, v15, 4, v14
    v_and_b32 v12, 1, v1
    v_lshl_add_u32 v8, v12, 3, v14
    v_xor_b32 v11, 64, v8
    v_add_u32 v4, 49152, v8
    v_add_u32 v5, 49152, v11
    v_add_u32 v6, 114688, v8
    v_add_u32 v7, 114688, v11
    v_lshlrev_b32 v9, 4, v1
    v_mov_b32 v104, 0
    v_mov_b32 v105, 0
    v_mov_b32 v106, 0
    v_mov_b32 v107, 0
    s_waitcnt lgkmcnt(0)
    v_rcp_f32 v108, v111
    s_mov_b32 exec_hi, 0
    v_cvt_pk_bf16_f32 v104, -v110, -v110
    v_lshrrev_b32 v105, 16, v111
    s_mov_b32 exec_hi, -1
    v_mul_f32 v109, v108, v108
    v_mul_f32 v109, v109, v108
    v_mul_f32 v109, 0xbdd2d3e8, v109
    v_mul_f32 v108, 0xc0135761, v108
    v_mov_b32 v110, v111
    s_lshl_b32 s60, s27, 1
    s_lshr_b32 s61, s31, 1
    s_add_u32 s60, s60, s61
    s_mul_i32 s60, s60, 360448
    s_and_b32 s61, s31, 1
    s_lshl_b32 s61, s61, 10
    s_add_u32 s60, s60, s61
    s_add_u32 s60, s60, 0
    v_lshlrev_b32 v10, 3, v2
    v_add_u32 v10, 20480, v10
    s_mov_b32 exec_lo, 0
    v_mov_b32 v10, 21760
    s_mov_b32 exec_lo, -1
    v_mov_b32 v102, 0
    v_mov_b32 v103, 0
    s_lshl_b32 s63, s29, 13
    s_add_u32 s63, s63, s60
    s_add_u32 s63, s63, 131072
    ds_read_b64_tr_b16 v[80:81], v5 offset:0
    ds_read_b64_tr_b16 v[82:83], v5 offset:512
    ds_read_b64_tr_b16 v[84:85], v5 offset:2048
    ds_read_b64_tr_b16 v[86:87], v5 offset:2560
    ds_read_b64_tr_b16 v[88:89], v5 offset:4096
    ds_read_b64_tr_b16 v[90:91], v5 offset:4608
    ds_read_b64_tr_b16 v[92:93], v5 offset:6144
    ds_read_b64_tr_b16 v[94:95], v5 offset:6656
    ds_read_b64_tr_b16 v[96:97], v5 offset:8192
    ds_read_b64_tr_b16 v[98:99], v5 offset:8704
    s_waitcnt lgkmcnt(8)
    v_mfma_f32_32x32x16_bf16 v[16:31], v[80:83], a[0:3], 0
    ds_read_b64_tr_b16 v[80:81], v5 offset:10240
    ds_read_b64_tr_b16 v[82:83], v5 offset:10752
    s_waitcnt lgkmcnt(8)
    v_mfma_f32_32x32x16_bf16 v[16:31], v[84:87], a[4:7], v[16:31]
    ds_read_b64_tr_b16 v[84:85], v5 offset:12288
    ds_read_b64_tr_b16 v[86:87], v5 offset:12800
    s_waitcnt lgkmcnt(8)
    v_mfma_f32_32x32x16_bf16 v[16:31], v[88:91], a[8:11], v[16:31]
    ds_read_b64_tr_b16 v[88:89], v5 offset:14336
    ds_read_b64_tr_b16 v[90:91], v5 offset:14848
    s_waitcnt lgkmcnt(8)
    v_mfma_f32_32x32x16_bf16 v[16:31], v[92:95], a[12:15], v[16:31]
    ds_read_b64_tr_b16 v[92:93], v5 offset:16384
    ds_read_b64_tr_b16 v[94:95], v5 offset:16896
    s_waitcnt lgkmcnt(8)
    v_mfma_f32_32x32x16_bf16 v[16:31], v[96:99], a[16:19], v[16:31]
    ds_read_b64_tr_b16 v[96:97], v5 offset:18432
    ds_read_b64_tr_b16 v[98:99], v5 offset:18944
    s_waitcnt lgkmcnt(8)
    v_mfma_f32_32x32x16_bf16 v[16:31], v[80:83], a[20:23], v[16:31]
    ds_read_b64_tr_b16 v[80:81], v5 offset:20480
    ds_read_b64_tr_b16 v[82:83], v5 offset:20992
    s_waitcnt lgkmcnt(8)
    v_mfma_f32_32x32x16_bf16 v[16:31], v[84:87], a[24:27], v[16:31]
    ds_read_b64_tr_b16 v[84:85], v5 offset:22528
    ds_read_b64_tr_b16 v[86:87], v5 offset:23040
    s_waitcnt lgkmcnt(8)
    v_mfma_f32_32x32x16_bf16 v[16:31], v[88:91], a[28:31], v[16:31]
    ds_read_b64_tr_b16 v[88:89], v5 offset:24576
    ds_read_b64_tr_b16 v[90:91], v5 offset:25088
    s_waitcnt lgkmcnt(8)
    v_mfma_f32_32x32x16_bf16 v[16:31], v[92:95], a[32:35], v[16:31]
    ds_read_b64_tr_b16 v[92:93], v5 offset:26624
    ds_read_b64_tr_b16 v[94:95], v5 offset:27136
    s_waitcnt lgkmcnt(8)
    v_mfma_f32_32x32x16_bf16 v[16:31], v[96:99], a[36:39], v[16:31]
    ds_read_b64_tr_b16 v[96:97], v5 offset:28672
    ds_read_b64_tr_b16 v[98:99], v5 offset:29184
    s_waitcnt lgkmcnt(8)
    v_mfma_f32_32x32x16_bf16 v[16:31], v[80:83], a[40:43], v[16:31]
    ds_read_b64_tr_b16 v[80:81], v5 offset:30720
    ds_read_b64_tr_b16 v[82:83], v5 offset:31232
    s_waitcnt lgkmcnt(8)
    v_mfma_f32_32x32x16_bf16 v[16:31], v[84:87], a[44:47], v[16:31]
    ds_read_b64_tr_b16 v[84:85], v5 offset:32768
    ds_read_b64_tr_b16 v[86:87], v5 offset:33280
    s_waitcnt lgkmcnt(8)
    v_mfma_f32_32x32x16_bf16 v[16:31], v[88:91], a[48:51], v[16:31]
    ds_read_b64_tr_b16 v[88:89], v5 offset:34816
    ds_read_b64_tr_b16 v[90:91], v5 offset:35328
    s_waitcnt lgkmcnt(8)
    v_mfma_f32_32x32x16_bf16 v[16:31], v[92:95], a[52:55], v[16:31]
    ds_read_b64_tr_b16 v[92:93], v5 offset:36864
    ds_read_b64_tr_b16 v[94:95], v5 offset:37376
    s_waitcnt lgkmcnt(8)
    v_mfma_f32_32x32x16_bf16 v[16:31], v[96:99], a[56:59], v[16:31]
    ds_read_b64_tr_b16 v[96:97], v5 offset:38912
    ds_read_b64_tr_b16 v[98:99], v5 offset:39424
    s_waitcnt lgkmcnt(8)
    v_mfma_f32_32x32x16_bf16 v[16:31], v[80:83], a[60:63], v[16:31]
    ds_read_b64_tr_b16 v[80:81], v5 offset:40960
    ds_read_b64_tr_b16 v[82:83], v5 offset:41472
    s_waitcnt lgkmcnt(8)
    v_mfma_f32_32x32x16_bf16 v[16:31], v[84:87], a[64:67], v[16:31]
    ds_read_b64_tr_b16 v[84:85], v5 offset:43008
    ds_read_b64_tr_b16 v[86:87], v5 offset:43520
    s_waitcnt lgkmcnt(8)
    v_mfma_f32_32x32x16_bf16 v[16:31], v[88:91], a[68:71], v[16:31]
    ds_read_b64_tr_b16 v[88:89], v5 offset:45056
    ds_read_b64_tr_b16 v[90:91], v5 offset:45568
    s_waitcnt lgkmcnt(8)
    v_mfma_f32_32x32x16_bf16 v[16:31], v[92:95], a[72:75], v[16:31]
    ds_read_b64_tr_b16 v[92:93], v5 offset:47104
    ds_read_b64_tr_b16 v[94:95], v5 offset:47616
    s_waitcnt lgkmcnt(8)
    v_mfma_f32_32x32x16_bf16 v[16:31], v[96:99], a[76:79], v[16:31]
    ds_read_b64_tr_b16 v[96:97], v5 offset:49152
    ds_read_b64_tr_b16 v[98:99], v5 offset:49664
    s_waitcnt lgkmcnt(8)
    v_mfma_f32_32x32x16_bf16 v[16:31], v[80:83], a[80:83], v[16:31]
    ds_read_b64_tr_b16 v[80:81], v5 offset:51200
    ds_read_b64_tr_b16 v[82:83], v5 offset:51712
    s_waitcnt lgkmcnt(8)
    v_mfma_f32_32x32x16_bf16 v[16:31], v[84:87], a[84:87], v[16:31]
    ds_read_b64_tr_b16 v[84:85], v5 offset:53248
    ds_read_b64_tr_b16 v[86:87], v5 offset:53760
    s_waitcnt lgkmcnt(8)
    v_mfma_f32_32x32x16_bf16 v[16:31], v[88:91], a[88:91], v[16:31]
    ds_read_b64_tr_b16 v[88:89], v5 offset:55296
    ds_read_b64_tr_b16 v[90:91], v5 offset:55808
    s_waitcnt lgkmcnt(8)
    v_mfma_f32_32x32x16_bf16 v[16:31], v[92:95], a[92:95], v[16:31]
    s_barrier
    s_cmp_lg_u32 s24, 1
    s_cbranch_scc1 parallel_sum__ssm_conv_s5__dense_activation_gelu__prompt_kernel_nocnt
    s_mov_b64 exec, 1
    v_mov_b32 v114, 1
    v_mov_b32 v115, 0
    buffer_atomic_add v114, v115, s[36:39], 0 offen sc0 sc1
    s_mov_b64 exec, -1
parallel_sum__ssm_conv_s5__dense_activation_gelu__prompt_kernel_nocnt:
    ds_read_b64_tr_b16 v[92:93], v5 offset:57344
    ds_read_b64_tr_b16 v[94:95], v5 offset:57856
    s_waitcnt lgkmcnt(8)
    v_mfma_f32_32x32x16_bf16 v[16:31], v[96:99], a[96:99], v[16:31]
    ds_read_b64 v[100:101], v10 offset:256
    ds_read_b64_tr_b16 v[96:97], v5 offset:59392
    ds_read_b64_tr_b16 v[98:99], v5 offset:59904
    s_waitcnt lgkmcnt(9)
    v_mfma_f32_32x32x16_bf16 v[16:31], v[80:83], a[100:103], v[16:31]
    ds_read_b64_tr_b16 v[80:81], v5 offset:61440
    ds_read_b64_tr_b16 v[82:83], v5 offset:61952
    s_waitcnt lgkmcnt(9)
    v_mfma_f32_32x32x16_bf16 v[16:31], v[84:87], a[104:107], v[16:31]
    ds_read_b64_tr_b16 v[84:85], v5 offset:63488
    ds_read_b64_tr_b16 v[86:87], v5 offset:64000
    s_waitcnt lgkmcnt(9)
    v_mfma_f32_32x32x16_bf16 v[16:31], v[88:91], a[108:111], v[16:31]
    s_waitcnt lgkmcnt(7)
    v_mfma_f32_32x32x16_bf16 v[16:31], v[92:95], a[112:115], v[16:31]
    s_waitcnt lgkmcnt(4)
    v_mfma_f32_32x32x16_bf16 v[16:31], v[96:99], a[116:119], v[16:31]
    s_waitcnt lgkmcnt(2)
    v_mfma_f32_32x32x16_bf16 v[16:31], v[80:83], a[120:123], v[16:31]
    s_waitcnt lgkmcnt(0)
    v_mfma_f32_32x32x16_bf16 v[16:31], v[84:87], a[124:127], v[16:31]
    v_mfma_f32_32x32x16_bf16 v[16:31], v[100:103], v[104:107], v[16:31]
    s_cmp_lg_u32 s24, 3
    s_cbranch_scc1 parallel_sum__ssm_conv_s5__dense_activation_gelu__prompt_kernel_noe
    s_nop 7
    v_lshlrev_b32 v12, 13, v3
    v_lshl_add_u32 v12, v2, 4, v12
    s_lshl_b32 s54, s28, 9
    s_add_u32 s54, s54, 14778368
    buffer_load_dwordx4 a[0:3], v12, s[32:35], s54 offen sc1
    s_add_u32 s54, s54, 16384
    buffer_load_dwordx4 a[4:7], v12, s[32:35], s54 offen sc1
    s_add_u32 s54, s54, 16384
    buffer_load_dwordx4 a[8:11], v12, s[32:35], s54 offen sc1
    s_add_u32 s54, s54, 16384
    buffer_load_dwordx4 a[12:15], v12, s[32:35], s54 offen sc1
    s_add_u32 s54, s54, 16384
    buffer_load_dwordx4 a[16:19], v12, s[32:35], s54 offen sc1
    s_add_u32 s54, s54, 16384
    buffer_load_dwordx4 a[20:23], v12, s[32:35], s54 offen sc1
    s_add_u32 s54, s54, 16384
    buffer_load_dwordx4 a[24:27], v12, s[32:35], s54 offen sc1
    s_add_u32 s54, s54, 16384
    buffer_load_dwordx4 a[28:31], v12, s[32:35], s54 offen sc1
    s_add_u32 s54, s54, 16384
parallel_sum__ssm_conv_s5__dense_activation_gelu__prompt_kernel_noe:
    s_nop 9
    v_mul_f32 v32, v16, v16
    v_mul_f32 v33, v17, v17
    v_mul_f32 v34, v18, v18
    v_mul_f32 v35, v19, v19
    v_fma_f32 v32, v32, v109, v108
    v_fma_f32 v33, v33, v109, v108
    v_fma_f32 v34, v34, v109, v108
    v_fma_f32 v35, v35, v109, v108
    v_mul_f32 v32, v32, v16
    v_mul_f32 v33, v33, v17
    v_mul_f32 v34, v34, v18
    v_mul_f32 v35, v35, v19
    v_exp_f32 v32, v32
    v_exp_f32 v33, v33
    v_exp_f32 v34, v34
    v_exp_f32 v35, v35
    v_fma_f32 v32, v32, v110, v110
    v_fma_f32 v33, v33, v110, v110
    v_fma_f32 v34, v34, v110, v110
    v_fma_f32 v35, v35, v110, v110
    v_rcp_f32 v32, v32
    v_rcp_f32 v33, v33
    v_rcp_f32 v34, v34
    v_rcp_f32 v35, v35
    v_mul_f32 v32, v32, v16
    v_mul_f32 v33, v33, v17
    v_mul_f32 v34, v34, v18
    v_mul_f32 v35, v35, v19
    v_cvt_pk_bf16_f32 v32, v32, v33
    v_cvt_pk_bf16_f32 v33, v34, v35
    v_mul_f32 v36, v20, v20
    v_mul_f32 v37, v21, v21
    v_mul_f32 v38, v22, v22
    v_mul_f32 v39, v23, v23
    v_fma_f32 v36, v36, v109, v108
    v_fma_f32 v37, v37, v109, v108
    v_fma_f32 v38, v38, v109, v108
    v_fma_f32 v39, v39, v109, v108
    v_mul_f32 v36, v36, v20
    v_mul_f32 v37, v37, v21
    v_mul_f32 v38, v38, v22
    v_mul_f32 v39, v39, v23
    v_exp_f32 v36, v36
    v_exp_f32 v37, v37
    v_exp_f32 v38, v38
    v_exp_f32 v39, v39
    v_fma_f32 v36, v36, v110, v110
    v_fma_f32 v37, v37, v110, v110
    v_fma_f32 v38, v38, v110, v110
    v_fma_f32 v39, v39, v110, v110
    v_rcp_f32 v36, v36
    v_rcp_f32 v37, v37
    v_rcp_f32 v38, v38
    v_rcp_f32 v39, v39
    v_mul_f32 v36, v36, v20
    v_mul_f32 v37, v37, v21
    v_mul_f32 v38, v38, v22
    v_mul_f32 v39, v39, v23
    v_cvt_pk_bf16_f32 v36, v36, v37
    v_cvt_pk_bf16_f32 v37, v38, v39
    v_mov_b32 v34, v36
    v_mov_b32 v35, v37
    s_add_u32 s61, s63, 4096
    buffer_store_dwordx4 v[32:35], v9, s[32:35], s61 offen sc0 sc1
    v_mul_f32 v40, v24, v24
    v_mul_f32 v41, v25, v25
    v_mul_f32 v42, v26, v26
    v_mul_f32 v43, v27, v27
    v_fma_f32 v40, v40, v109, v108
    v_fma_f32 v41, v41, v109, v108
    v_fma_f32 v42, v42, v109, v108
    v_fma_f32 v43, v43, v109, v108
    v_mul_f32 v40, v40, v24
    v_mul_f32 v41, v41, v25
    v_mul_f32 v42, v42, v26
    v_mul_f32 v43, v43, v27
    v_exp_f32 v40, v40
    v_exp_f32 v41, v41
    v_exp_f32 v42, v42
    v_exp_f32 v43, v43
    v_fma_f32 v40, v40, v110, v110
    v_fma_f32 v41, v41, v110, v110
    v_fma_f32 v42, v42, v110, v110
    v_fma_f32 v43, v43, v110, v110
    v_rcp_f32 v40, v40
    v_rcp_f32 v41, v41
    v_rcp_f32 v42, v42
    v_rcp_f32 v43, v43
    v_mul_f32 v40, v40, v24
    v_mul_f32 v41, v41, v25
    v_mul_f32 v42, v42, v26
    v_mul_f32 v43, v43, v27
    v_cvt_pk_bf16_f32 v40, v40, v41
    v_cvt_pk_bf16_f32 v41, v42, v43
    v_mul_f32 v44, v28, v28
    v_mul_f32 v45, v29, v29
    v_mul_f32 v46, v30, v30
    v_mul_f32 v47, v31, v31
    v_fma_f32 v44, v44, v109, v108
    v_fma_f32 v45, v45, v109, v108
    v_fma_f32 v46, v46, v109, v108
    v_fma_f32 v47, v47, v109, v108
    v_mul_f32 v44, v44, v28
    v_mul_f32 v45, v45, v29
    v_mul_f32 v46, v46, v30
    v_mul_f32 v47, v47, v31
    v_exp_f32 v44, v44
    v_exp_f32 v45, v45
    v_exp_f32 v46, v46
    v_exp_f32 v47, v47
    v_fma_f32 v44, v44, v110, v110
    v_fma_f32 v45, v45, v110, v110
    v_fma_f32 v46, v46, v110, v110
    v_fma_f32 v47, v47, v110, v110
    v_rcp_f32 v44, v44
    v_rcp_f32 v45, v45
    v_rcp_f32 v46, v46
    v_rcp_f32 v47, v47
    v_mul_f32 v44, v44, v28
    v_mul_f32 v45, v45, v29
    v_mul_f32 v46, v46, v30
    v_mul_f32 v47, v47, v31
    v_cvt_pk_bf16_f32 v44, v44, v45
    v_cvt_pk_bf16_f32 v45, v46, v47
    v_mov_b32 v42, v44
    v_mov_b32 v43, v45
    s_add_u32 s61, s63, 6144
    buffer_store_dwordx4 v[40:43], v9, s[32:35], s61 offen sc0 sc1
    s_cmp_lg_u32 s24, 3
    s_waitcnt vmcnt(2)
    s_cbranch_scc1 parallel_sum__ssm_conv_s5__dense_activation_gelu__prompt_kernel_waitl
    s_mov_b32 s62, 0
parallel_sum__ssm_conv_s5__dense_activation_gelu__prompt_kernel_echk:
    s_waitcnt vmcnt(0)
    v_mov_b32 v16, 0
    s_sub_i32 s55, s27, 0
    s_max_i32 s55, s55, 0
    v_cmp_gt_u32 s[64:65], s55, v3
    v_accvgpr_read_b32 v17, a1
    v_accvgpr_read_b32 v18, a3
    v_xor_b32 v17, s93, v17
    v_xor_b32 v18, s93, v18
    v_or_b32 v17, v17, v18
    v_cndmask_b32 v17, 0, v17, s[64:65]
    v_or_b32 v16, v16, v17
    s_sub_i32 s55, s27, 2
    s_max_i32 s55, s55, 0
    v_cmp_gt_u32 s[64:65], s55, v3
    v_accvgpr_read_b32 v17, a5
    v_accvgpr_read_b32 v18, a7
    v_xor_b32 v17, s93, v17
    v_xor_b32 v18, s93, v18
    v_or_b32 v17, v17, v18
    v_cndmask_b32 v17, 0, v17, s[64:65]
    v_or_b32 v16, v16, v17
    s_sub_i32 s55, s27, 4
    s_max_i32 s55, s55, 0
    v_cmp_gt_u32 s[64:65], s55, v3
    v_accvgpr_read_b32 v17, a9
    v_accvgpr_read_b32 v18, a11
    v_xor_b32 v17, s93, v17
    v_xor_b32 v18, s93, v18
    v_or_b32 v17, v17, v18
    v_cndmask_b32 v17, 0, v17, s[64:65]
    v_or_b32 v16, v16, v17
    s_sub_i32 s55, s27, 6
    s_max_i32 s55, s55, 0
    v_cmp_gt_u32 s[64:65], s55, v3
    v_accvgpr_read_b32 v17, a13
    v_accvgpr_read_b32 v18, a15
    v_xor_b32 v17, s93, v17
    v_xor_b32 v18, s93, v18
    v_or_b32 v17, v17, v18
    v_cndmask_b32 v17, 0, v17, s[64:65]
    v_or_b32 v16, v16, v17
    s_sub_i32 s55, s27, 8
    s_max_i32 s55, s55, 0
    v_cmp_gt_u32 s[64:65], s55, v3
    v_accvgpr_read_b32 v17, a17
    v_accvgpr_read_b32 v18, a19
    v_xor_b32 v17, s93, v17
    v_xor_b32 v18, s93, v18
    v_or_b32 v17, v17, v18
    v_cndmask_b32 v17, 0, v17, s[64:65]
    v_or_b32 v16, v16, v17
    s_sub_i32 s55, s27, 10
    s_max_i32 s55, s55, 0
    v_cmp_gt_u32 s[64:65], s55, v3
    v_accvgpr_read_b32 v17, a21
    v_accvgpr_read_b32 v18, a23
    v_xor_b32 v17, s93, v17
    v_xor_b32 v18, s93, v18
    v_or_b32 v17, v17, v18
    v_cndmask_b32 v17, 0, v17, s[64:65]
    v_or_b32 v16, v16, v17
    s_sub_i32 s55, s27, 12
    s_max_i32 s55, s55, 0
    v_cmp_gt_u32 s[64:65], s55, v3
    v_accvgpr_read_b32 v17, a25
    v_accvgpr_read_b32 v18, a27
    v_xor_b32 v17, s93, v17
    v_xor_b32 v18, s93, v18
    v_or_b32 v17, v17, v18
    v_cndmask_b32 v17, 0, v17, s[64:65]
    v_or_b32 v16, v16, v17
    s_sub_i32 s55, s27, 14
    s_max_i32 s55, s55, 0
    v_cmp_gt_u32 s[64:65], s55, v3
    v_accvgpr_read_b32 v17, a29
    v_accvgpr_read_b32 v18, a31
    v_xor_b32 v17, s93, v17
    v_xor_b32 v18, s93, v18
    v_or_b32 v17, v17, v18
    v_cndmask_b32 v17, 0, v17, s[64:65]
    v_or_b32 v16, v16, v17
    v_cmp_ne_u32 s[64:65], 0, v16
    s_nop 2
    s_cmp_eq_u64 s[64:65], 0
    s_cbranch_scc1 parallel_sum__ssm_conv_s5__dense_activation_gelu__prompt_kernel_eok
    s_add_u32 s62, s62, 1
    s_cmp_gt_u32 s62, 100000
    s_cbranch_scc1 parallel_sum__ssm_conv_s5__dense_activation_gelu__prompt_kernel_eok
    s_sleep 2
    v_lshlrev_b32 v12, 13, v3
    v_lshl_add_u32 v12, v2, 4, v12
    s_lshl_b32 s54, s28, 9
    s_add_u32 s54, s54, 14778368
    buffer_load_dwordx4 a[0:3], v12, s[32:35], s54 offen sc1
    s_add_u32 s54, s54, 16384
    buffer_load_dwordx4 a[4:7], v12, s[32:35], s54 offen sc1
    s_add_u32 s54, s54, 16384
    buffer_load_dwordx4 a[8:11], v12, s[32:35], s54 offen sc1
    s_add_u32 s54, s54, 16384
    buffer_load_dwordx4 a[12:15], v12, s[32:35], s54 offen sc1
    s_add_u32 s54, s54, 16384
    buffer_load_dwordx4 a[16:19], v12, s[32:35], s54 offen sc1
    s_add_u32 s54, s54, 16384
    buffer_load_dwordx4 a[20:23], v12, s[32:35], s54 offen sc1
    s_add_u32 s54, s54, 16384
    buffer_load_dwordx4 a[24:27], v12, s[32:35], s54 offen sc1
    s_add_u32 s54, s54, 16384
    buffer_load_dwordx4 a[28:31], v12, s[32:35], s54 offen sc1
    s_add_u32 s54, s54, 16384
    s_branch parallel_sum__ssm_conv_s5__dense_activation_gelu__prompt_kernel_echk
    s_waitcnt vmcnt(0)
parallel_sum__ssm_conv_s5__dense_activation_gelu__prompt_kernel_eok:
    v_lshlrev_b32 v14, 8, v3
    v_lshl_add_u32 v14, v2, 3, v14
    v_add_u32 v14, 24576, v14
    ds_write_b32 v14, a0 offset:0
    ds_write_b32 v14, a2 offset:4
    ds_write_b32 v14, a4 offset:512
    ds_write_b32 v14, a6 offset:516
    ds_write_b32 v14, a8 offset:1024
    ds_write_b32 v14, a10 offset:1028
    ds_write_b32 v14, a12 offset:1536
    ds_write_b32 v14, a14 offset:1540
    ds_write_b32 v14, a16 offset:2048
    ds_write_b32 v14, a18 offset:2052
    ds_write_b32 v14, a20 offset:2560
    ds_write_b32 v14, a22 offset:2564
    ds_write_b32 v14, a24 offset:3072
    ds_write_b32 v14, a26 offset:3076
    ds_write_b32 v14, a28 offset:3584
    ds_write_b32 v14, a30 offset:3588
    v_mov_b32 v12, 21504
    v_mov_b32 v13, 1
    s_waitcnt lgkmcnt(0)
    ds_write_b32 v12, v13
    s_waitcnt lgkmcnt(0)
    s_branch parallel_sum__ssm_conv_s5__dense_activation_gelu__prompt_kernel_waitl_done
parallel_sum__ssm_conv_s5__dense_activation_gelu__prompt_kernel_waitl:
    v_mov_b32 v12, 21504
    s_mov_b32 s62, 0
parallel_sum__ssm_conv_s5__dense_activation_gelu__prompt_kernel_waitl_l:
    ds_read_b32 v13, v12
    s_waitcnt lgkmcnt(0)
    v_readfirstlane_b32 s55, v13
    s_nop 2
    s_cmp_eq_u32 s55, 1
    s_cbranch_scc1 parallel_sum__ssm_conv_s5__dense_activation_gelu__prompt_kernel_waitl_done
    s_add_u32 s62, s62, 1
    s_cmp_gt_u32 s62, 2000000
    s_cbranch_scc1 parallel_sum__ssm_conv_s5__dense_activation_gelu__prompt_kernel_waitl_done
    s_sleep 1
    s_branch parallel_sum__ssm_conv_s5__dense_activation_gelu__prompt_kernel_waitl_l
parallel_sum__ssm_conv_s5__dense_activation_gelu__prompt_kernel_waitl_done:
    s_setprio 3
    v_lshlrev_b32 v13, 3, v2
    v_add_u32 v13, 24576, v13
    ds_read_b64 v[16:17], v13 offset:0
    ds_read_b64 v[18:19], v13 offset:256
    ds_read_b64 v[20:21], v13 offset:512
    ds_read_b64 v[22:23], v13 offset:768
    ds_read_b64 v[24:25], v13 offset:1024
    ds_read_b64 v[26:27], v13 offset:1280
    ds_read_b64 v[28:29], v13 offset:1536
    ds_read_b64 v[30:31], v13 offset:1792
    ds_read_b64 v[32:33], v13 offset:2048
    ds_read_b64 v[34:35], v13 offset:2304
    ds_read_b64 v[36:37], v13 offset:2560
    ds_read_b64 v[38:39], v13 offset:2816
    ds_read_b64 v[40:41], v13 offset:3072
    ds_read_b64 v[42:43], v13 offset:3328
    ds_read_b64 v[44:45], v13 offset:3584
    v_mov_b32 v96, 0
    v_mov_b32 v97, 0
    s_lshl_b32 s54, s31, 12
    s_add_u32 s54, s54, 28672
    v_lshrrev_b32 v12, 2, v2
    v_lshlrev_b32 v13, 1, v3
    v_xor_b32 v12, v12, v13
    v_and_b32 v13, 3, v2
    v_lshlrev_b32 v13, 2, v13
    v_lshl_add_u32 v13, v3, 9, v13
    v_add_u32 v13, s54, v13
    v_xor_b32 v14, 0, v12
    v_lshl_add_u32 v4, v14, 4, v13
    v_xor_b32 v14, 1, v12
    v_lshl_add_u32 v5, v14, 4, v13
    v_xor_b32 v14, 4, v12
    v_lshl_add_u32 v6, v14, 4, v13
    v_xor_b32 v14, 5, v12
    v_lshl_add_u32 v7, v14, 4, v13
    s_waitcnt lgkmcnt(0)
    s_cmp_le_u32 s27, 0
    s_cbranch_scc1 parallel_sum__ssm_conv_s5__dense_activation_gelu__prompt_kernel_hdone
    v_pk_fma_f32 v[98:99], v[120:121], v[96:97], v[16:17] op_sel:[0,0,0] op_sel_hi:[0,1,1]
    v_pk_fma_f32 v[96:97], v[120:121], v[96:97], v[98:99] op_sel:[1,1,0] op_sel_hi:[1,0,1] neg_lo:[1,0,0]
    s_cmp_le_u32 s27, 1
    s_cbranch_scc1 parallel_sum__ssm_conv_s5__dense_activation_gelu__prompt_kernel_hdone
    v_pk_fma_f32 v[98:99], v[120:121], v[96:97], v[18:19] op_sel:[0,0,0] op_sel_hi:[0,1,1]
    v_pk_fma_f32 v[96:97], v[120:121], v[96:97], v[98:99] op_sel:[1,1,0] op_sel_hi:[1,0,1] neg_lo:[1,0,0]
    s_cmp_le_u32 s27, 2
    s_cbranch_scc1 parallel_sum__ssm_conv_s5__dense_activation_gelu__prompt_kernel_hdone
    v_pk_fma_f32 v[98:99], v[120:121], v[96:97], v[20:21] op_sel:[0,0,0] op_sel_hi:[0,1,1]
    v_pk_fma_f32 v[96:97], v[120:121], v[96:97], v[98:99] op_sel:[1,1,0] op_sel_hi:[1,0,1] neg_lo:[1,0,0]
    s_cmp_le_u32 s27, 3
    s_cbranch_scc1 parallel_sum__ssm_conv_s5__dense_activation_gelu__prompt_kernel_hdone
    v_pk_fma_f32 v[98:99], v[120:121], v[96:97], v[22:23] op_sel:[0,0,0] op_sel_hi:[0,1,1]
    v_pk_fma_f32 v[96:97], v[120:121], v[96:97], v[98:99] op_sel:[1,1,0] op_sel_hi:[1,0,1] neg_lo:[1,0,0]
    s_cmp_le_u32 s27, 4
    s_cbranch_scc1 parallel_sum__ssm_conv_s5__dense_activation_gelu__prompt_kernel_hdone
    v_pk_fma_f32 v[98:99], v[120:121], v[96:97], v[24:25] op_sel:[0,0,0] op_sel_hi:[0,1,1]
    v_pk_fma_f32 v[96:97], v[120:121], v[96:97], v[98:99] op_sel:[1,1,0] op_sel_hi:[1,0,1] neg_lo:[1,0,0]
    s_cmp_le_u32 s27, 5
    s_cbranch_scc1 parallel_sum__ssm_conv_s5__dense_activation_gelu__prompt_kernel_hdone
    v_pk_fma_f32 v[98:99], v[120:121], v[96:97], v[26:27] op_sel:[0,0,0] op_sel_hi:[0,1,1]
    v_pk_fma_f32 v[96:97], v[120:121], v[96:97], v[98:99] op_sel:[1,1,0] op_sel_hi:[1,0,1] neg_lo:[1,0,0]
    s_cmp_le_u32 s27, 6
    s_cbranch_scc1 parallel_sum__ssm_conv_s5__dense_activation_gelu__prompt_kernel_hdone
    v_pk_fma_f32 v[98:99], v[120:121], v[96:97], v[28:29] op_sel:[0,0,0] op_sel_hi:[0,1,1]
    v_pk_fma_f32 v[96:97], v[120:121], v[96:97], v[98:99] op_sel:[1,1,0] op_sel_hi:[1,0,1] neg_lo:[1,0,0]
    s_cmp_le_u32 s27, 7
    s_cbranch_scc1 parallel_sum__ssm_conv_s5__dense_activation_gelu__prompt_kernel_hdone
    v_pk_fma_f32 v[98:99], v[120:121], v[96:97], v[30:31] op_sel:[0,0,0] op_sel_hi:[0,1,1]
    v_pk_fma_f32 v[96:97], v[120:121], v[96:97], v[98:99] op_sel:[1,1,0] op_sel_hi:[1,0,1] neg_lo:[1,0,0]
    s_cmp_le_u32 s27, 8
    s_cbranch_scc1 parallel_sum__ssm_conv_s5__dense_activation_gelu__prompt_kernel_hdone
    v_pk_fma_f32 v[98:99], v[120:121], v[96:97], v[32:33] op_sel:[0,0,0] op_sel_hi:[0,1,1]
    v_pk_fma_f32 v[96:97], v[120:121], v[96:97], v[98:99] op_sel:[1,1,0] op_sel_hi:[1,0,1] neg_lo:[1,0,0]
    s_cmp_le_u32 s27, 9
    s_cbranch_scc1 parallel_sum__ssm_conv_s5__dense_activation_gelu__prompt_kernel_hdone
    v_pk_fma_f32 v[98:99], v[120:121], v[96:97], v[34:35] op_sel:[0,0,0] op_sel_hi:[0,1,1]
    v_pk_fma_f32 v[96:97], v[120:121], v[96:97], v[98:99] op_sel:[1,1,0] op_sel_hi:[1,0,1] neg_lo:[1,0,0]
    s_cmp_le_u32 s27, 10
    s_cbranch_scc1 parallel_sum__ssm_conv_s5__dense_activation_gelu__prompt_kernel_hdone
    v_pk_fma_f32 v[98:99], v[120:121], v[96:97], v[36:37] op_sel:[0,0,0] op_sel_hi:[0,1,1]
    v_pk_fma_f32 v[96:97], v[120:121], v[96:97], v[98:99] op_sel:[1,1,0] op_sel_hi:[1,0,1] neg_lo:[1,0,0]
    s_cmp_le_u32 s27, 11
    s_cbranch_scc1 parallel_sum__ssm_conv_s5__dense_activation_gelu__prompt_kernel_hdone
    v_pk_fma_f32 v[98:99], v[120:121], v[96:97], v[38:39] op_sel:[0,0,0] op_sel_hi:[0,1,1]
    v_pk_fma_f32 v[96:97], v[120:121], v[96:97], v[98:99] op_sel:[1,1,0] op_sel_hi:[1,0,1] neg_lo:[1,0,0]
    s_cmp_le_u32 s27, 12
    s_cbranch_scc1 parallel_sum__ssm_conv_s5__dense_activation_gelu__prompt_kernel_hdone
    v_pk_fma_f32 v[98:99], v[120:121], v[96:97], v[40:41] op_sel:[0,0,0] op_sel_hi:[0,1,1]
    v_pk_fma_f32 v[96:97], v[120:121], v[96:97], v[98:99] op_sel:[1,1,0] op_sel_hi:[1,0,1] neg_lo:[1,0,0]
    s_cmp_le_u32 s27, 13
    s_cbranch_scc1 parallel_sum__ssm_conv_s5__dense_activation_gelu__prompt_kernel_hdone
    v_pk_fma_f32 v[98:99], v[120:121], v[96:97], v[42:43] op_sel:[0,0,0] op_sel_hi:[0,1,1]
    v_pk_fma_f32 v[96:97], v[120:121], v[96:97], v[98:99] op_sel:[1,1,0] op_sel_hi:[1,0,1] neg_lo:[1,0,0]
    s_cmp_le_u32 s27, 14
    s_cbranch_scc1 parallel_sum__ssm_conv_s5__dense_activation_gelu__prompt_kernel_hdone
    v_pk_fma_f32 v[98:99], v[120:121], v[96:97], v[44:45] op_sel:[0,0,0] op_sel_hi:[0,1,1]
    v_pk_fma_f32 v[96:97], v[120:121], v[96:97], v[98:99] op_sel:[1,1,0] op_sel_hi:[1,0,1] neg_lo:[1,0,0]
parallel_sum__ssm_conv_s5__dense_activation_gelu__prompt_kernel_hdone:
    v_pk_fma_f32 v[98:99], v[122:123], v[96:97], v[112:113] op_sel:[0,0,0] op_sel_hi:[0,1,1]
    v_pk_fma_f32 v[96:97], v[122:123], v[96:97], v[98:99] op_sel:[1,1,0] op_sel_hi:[1,0,1] neg_lo:[1,0,0]
    v_pk_fma_f32 v[98:99], v[116:117], v[96:97], v[48:49] op_sel:[0,0,0] op_sel_hi:[0,1,1]
    v_pk_fma_f32 v[96:97], v[116:117], v[96:97], v[98:99] op_sel:[1,1,0] op_sel_hi:[1,0,1] neg_lo:[1,0,0]
    v_pk_mul_f32 v[84:85], v[124:125], v[96:97] op_sel:[0,0] op_sel_hi:[0,1]
    v_pk_fma_f32 v[84:85], v[124:125], v[96:97], v[84:85] op_sel:[1,1,0] op_sel_hi:[1,0,1] neg_lo:[1,0,0]
    v_cvt_pk_bf16_f32 v16, v84, -v85
    ds_write_b32 v4, v16 offset:0
    v_pk_fma_f32 v[98:99], v[116:117], v[96:97], v[50:51] op_sel:[0,0,0] op_sel_hi:[0,1,1]
    v_pk_fma_f32 v[96:97], v[116:117], v[96:97], v[98:99] op_sel:[1,1,0] op_sel_hi:[1,0,1] neg_lo:[1,0,0]
    v_pk_mul_f32 v[84:85], v[124:125], v[96:97] op_sel:[0,0] op_sel_hi:[0,1]
    v_pk_fma_f32 v[84:85], v[124:125], v[96:97], v[84:85] op_sel:[1,1,0] op_sel_hi:[1,0,1] neg_lo:[1,0,0]
    v_cvt_pk_bf16_f32 v17, v84, -v85
    ds_write_b32 v4, v17 offset:128
    v_pk_fma_f32 v[98:99], v[116:117], v[96:97], v[52:53] op_sel:[0,0,0] op_sel_hi:[0,1,1]
    v_pk_fma_f32 v[96:97], v[116:117], v[96:97], v[98:99] op_sel:[1,1,0] op_sel_hi:[1,0,1] neg_lo:[1,0,0]
    v_pk_mul_f32 v[84:85], v[124:125], v[96:97] op_sel:[0,0] op_sel_hi:[0,1]
    v_pk_fma_f32 v[84:85], v[124:125], v[96:97], v[84:85] op_sel:[1,1,0] op_sel_hi:[1,0,1] neg_lo:[1,0,0]
    v_cvt_pk_bf16_f32 v18, v84, -v85
    ds_write_b32 v5, v18 offset:256
    v_pk_fma_f32 v[98:99], v[116:117], v[96:97], v[54:55] op_sel:[0,0,0] op_sel_hi:[0,1,1]
    v_pk_fma_f32 v[96:97], v[116:117], v[96:97], v[98:99] op_sel:[1,1,0] op_sel_hi:[1,0,1] neg_lo:[1,0,0]
    v_pk_mul_f32 v[84:85], v[124:125], v[96:97] op_sel:[0,0] op_sel_hi:[0,1]
    v_pk_fma_f32 v[84:85], v[124:125], v[96:97], v[84:85] op_sel:[1,1,0] op_sel_hi:[1,0,1] neg_lo:[1,0,0]
    v_cvt_pk_bf16_f32 v19, v84, -v85
    ds_write_b32 v5, v19 offset:384
    v_pk_fma_f32 v[98:99], v[116:117], v[96:97], v[56:57] op_sel:[0,0,0] op_sel_hi:[0,1,1]
    v_pk_fma_f32 v[96:97], v[116:117], v[96:97], v[98:99] op_sel:[1,1,0] op_sel_hi:[1,0,1] neg_lo:[1,0,0]
    v_pk_mul_f32 v[84:85], v[124:125], v[96:97] op_sel:[0,0] op_sel_hi:[0,1]
    v_pk_fma_f32 v[84:85], v[124:125], v[96:97], v[84:85] op_sel:[1,1,0] op_sel_hi:[1,0,1] neg_lo:[1,0,0]
    v_cvt_pk_bf16_f32 v20, v84, -v85
    ds_write_b32 v6, v20 offset:1024
    v_pk_fma_f32 v[98:99], v[116:117], v[96:97], v[58:59] op_sel:[0,0,0] op_sel_hi:[0,1,1]
    v_pk_fma_f32 v[96:97], v[116:117], v[96:97], v[98:99] op_sel:[1,1,0] op_sel_hi:[1,0,1] neg_lo:[1,0,0]
    v_pk_mul_f32 v[84:85], v[124:125], v[96:97] op_sel:[0,0] op_sel_hi:[0,1]
    v_pk_fma_f32 v[84:85], v[124:125], v[96:97], v[84:85] op_sel:[1,1,0] op_sel_hi:[1,0,1] neg_lo:[1,0,0]
    v_cvt_pk_bf16_f32 v21, v84, -v85
    ds_write_b32 v6, v21 offset:1152
    v_pk_fma_f32 v[98:99], v[116:117], v[96:97], v[60:61] op_sel:[0,0,0] op_sel_hi:[0,1,1]
    v_pk_fma_f32 v[96:97], v[116:117], v[96:97], v[98:99] op_sel:[1,1,0] op_sel_hi:[1,0,1] neg_lo:[1,0,0]
    v_pk_mul_f32 v[84:85], v[124:125], v[96:97] op_sel:[0,0] op_sel_hi:[0,1]
    v_pk_fma_f32 v[84:85], v[124:125], v[96:97], v[84:85] op_sel:[1,1,0] op_sel_hi:[1,0,1] neg_lo:[1,0,0]
    v_cvt_pk_bf16_f32 v22, v84, -v85
    ds_write_b32 v7, v22 offset:1280
    v_pk_fma_f32 v[98:99], v[116:117], v[96:97], v[62:63] op_sel:[0,0,0] op_sel_hi:[0,1,1]
    v_pk_fma_f32 v[96:97], v[116:117], v[96:97], v[98:99] op_sel:[1,1,0] op_sel_hi:[1,0,1] neg_lo:[1,0,0]
    v_pk_mul_f32 v[84:85], v[124:125], v[96:97] op_sel:[0,0] op_sel_hi:[0,1]
    v_pk_fma_f32 v[84:85], v[124:125], v[96:97], v[84:85] op_sel:[1,1,0] op_sel_hi:[1,0,1] neg_lo:[1,0,0]
    v_cvt_pk_bf16_f32 v23, v84, -v85
    ds_write_b32 v7, v23 offset:1408
    v_pk_fma_f32 v[98:99], v[116:117], v[96:97], v[64:65] op_sel:[0,0,0] op_sel_hi:[0,1,1]
    v_pk_fma_f32 v[96:97], v[116:117], v[96:97], v[98:99] op_sel:[1,1,0] op_sel_hi:[1,0,1] neg_lo:[1,0,0]
    v_pk_mul_f32 v[84:85], v[124:125], v[96:97] op_sel:[0,0] op_sel_hi:[0,1]
    v_pk_fma_f32 v[84:85], v[124:125], v[96:97], v[84:85] op_sel:[1,1,0] op_sel_hi:[1,0,1] neg_lo:[1,0,0]
    v_cvt_pk_bf16_f32 v24, v84, -v85
    ds_write_b32 v4, v24 offset:2048
    v_pk_fma_f32 v[98:99], v[116:117], v[96:97], v[66:67] op_sel:[0,0,0] op_sel_hi:[0,1,1]
    v_pk_fma_f32 v[96:97], v[116:117], v[96:97], v[98:99] op_sel:[1,1,0] op_sel_hi:[1,0,1] neg_lo:[1,0,0]
    v_pk_mul_f32 v[84:85], v[124:125], v[96:97] op_sel:[0,0] op_sel_hi:[0,1]
    v_pk_fma_f32 v[84:85], v[124:125], v[96:97], v[84:85] op_sel:[1,1,0] op_sel_hi:[1,0,1] neg_lo:[1,0,0]
    v_cvt_pk_bf16_f32 v25, v84, -v85
    ds_write_b32 v4, v25 offset:2176
    v_pk_fma_f32 v[98:99], v[116:117], v[96:97], v[68:69] op_sel:[0,0,0] op_sel_hi:[0,1,1]
    v_pk_fma_f32 v[96:97], v[116:117], v[96:97], v[98:99] op_sel:[1,1,0] op_sel_hi:[1,0,1] neg_lo:[1,0,0]
    v_pk_mul_f32 v[84:85], v[124:125], v[96:97] op_sel:[0,0] op_sel_hi:[0,1]
    v_pk_fma_f32 v[84:85], v[124:125], v[96:97], v[84:85] op_sel:[1,1,0] op_sel_hi:[1,0,1] neg_lo:[1,0,0]
    v_cvt_pk_bf16_f32 v26, v84, -v85
    ds_write_b32 v5, v26 offset:2304
    v_pk_fma_f32 v[98:99], v[116:117], v[96:97], v[70:71] op_sel:[0,0,0] op_sel_hi:[0,1,1]
    v_pk_fma_f32 v[96:97], v[116:117], v[96:97], v[98:99] op_sel:[1,1,0] op_sel_hi:[1,0,1] neg_lo:[1,0,0]
    v_pk_mul_f32 v[84:85], v[124:125], v[96:97] op_sel:[0,0] op_sel_hi:[0,1]
    v_pk_fma_f32 v[84:85], v[124:125], v[96:97], v[84:85] op_sel:[1,1,0] op_sel_hi:[1,0,1] neg_lo:[1,0,0]
    v_cvt_pk_bf16_f32 v27, v84, -v85
    ds_write_b32 v5, v27 offset:2432
    v_pk_fma_f32 v[98:99], v[116:117], v[96:97], v[72:73] op_sel:[0,0,0] op_sel_hi:[0,1,1]
    v_pk_fma_f32 v[96:97], v[116:117], v[96:97], v[98:99] op_sel:[1,1,0] op_sel_hi:[1,0,1] neg_lo:[1,0,0]
    v_pk_mul_f32 v[84:85], v[124:125], v[96:97] op_sel:[0,0] op_sel_hi:[0,1]
    v_pk_fma_f32 v[84:85], v[124:125], v[96:97], v[84:85] op_sel:[1,1,0] op_sel_hi:[1,0,1] neg_lo:[1,0,0]
    v_cvt_pk_bf16_f32 v28, v84, -v85
    ds_write_b32 v6, v28 offset:3072
    v_pk_fma_f32 v[98:99], v[116:117], v[96:97], v[74:75] op_sel:[0,0,0] op_sel_hi:[0,1,1]
    v_pk_fma_f32 v[96:97], v[116:117], v[96:97], v[98:99] op_sel:[1,1,0] op_sel_hi:[1,0,1] neg_lo:[1,0,0]
    v_pk_mul_f32 v[84:85], v[124:125], v[96:97] op_sel:[0,0] op_sel_hi:[0,1]
    v_pk_fma_f32 v[84:85], v[124:125], v[96:97], v[84:85] op_sel:[1,1,0] op_sel_hi:[1,0,1] neg_lo:[1,0,0]
    v_cvt_pk_bf16_f32 v29, v84, -v85
    ds_write_b32 v6, v29 offset:3200
    v_pk_fma_f32 v[98:99], v[116:117], v[96:97], v[76:77] op_sel:[0,0,0] op_sel_hi:[0,1,1]
    v_pk_fma_f32 v[96:97], v[116:117], v[96:97], v[98:99] op_sel:[1,1,0] op_sel_hi:[1,0,1] neg_lo:[1,0,0]
    v_pk_mul_f32 v[84:85], v[124:125], v[96:97] op_sel:[0,0] op_sel_hi:[0,1]
    v_pk_fma_f32 v[84:85], v[124:125], v[96:97], v[84:85] op_sel:[1,1,0] op_sel_hi:[1,0,1] neg_lo:[1,0,0]
    v_cvt_pk_bf16_f32 v30, v84, -v85
    ds_write_b32 v7, v30 offset:3328
    v_pk_fma_f32 v[98:99], v[116:117], v[96:97], v[78:79] op_sel:[0,0,0] op_sel_hi:[0,1,1]
    v_pk_fma_f32 v[96:97], v[116:117], v[96:97], v[98:99] op_sel:[1,1,0] op_sel_hi:[1,0,1] neg_lo:[1,0,0]
    v_pk_mul_f32 v[84:85], v[124:125], v[96:97] op_sel:[0,0] op_sel_hi:[0,1]
    v_pk_fma_f32 v[84:85], v[124:125], v[96:97], v[84:85] op_sel:[1,1,0] op_sel_hi:[1,0,1] neg_lo:[1,0,0]
    v_cvt_pk_bf16_f32 v31, v84, -v85
    ds_write_b32 v7, v31 offset:3456
    v_bfe_u32 v12, v2, 1, 3
    v_xor_b32 v12, v12, v3
    v_lshlrev_b32 v12, 4, v12
    v_lshl_add_u32 v12, v2, 7, v12
    v_add_u32 v12, s54, v12
    s_waitcnt lgkmcnt(0)
    v_xor_b32 v13, 0, v12
    ds_read_b128 v[64:67], v13
    v_xor_b32 v13, 32, v12
    ds_read_b128 v[68:71], v13
    v_xor_b32 v13, 64, v12
    ds_read_b128 v[72:75], v13
    v_xor_b32 v13, 96, v12
    ds_read_b128 v[76:79], v13
    s_lshl_b32 s61, s28, 13
    s_add_u32 s61, s61, s60
    s_waitcnt lgkmcnt(3)
    buffer_store_dwordx4 v[64:67], v9, s[32:35], s61 offen sc0 sc1
    s_add_u32 s61, s61, 2048
    s_waitcnt lgkmcnt(2)
    buffer_store_dwordx4 v[68:71], v9, s[32:35], s61 offen sc0 sc1
    s_add_u32 s61, s61, 2048
    s_waitcnt lgkmcnt(1)
    buffer_store_dwordx4 v[72:75], v9, s[32:35], s61 offen sc0 sc1
    s_add_u32 s61, s61, 2048
    s_waitcnt lgkmcnt(0)
    buffer_store_dwordx4 v[76:79], v9, s[32:35], s61 offen sc0 sc1
    s_add_u32 s61, s61, 2048
    s_branch parallel_sum__ssm_conv_s5__dense_activation_gelu__prompt_kernel_P2
parallel_sum__ssm_conv_s5__dense_activation_gelu__prompt_kernel_B:
    s_sub_u32 s24, s24, 4
    s_load_dwordx4 s[64:67], s[0:1], 40
    s_load_dwordx2 s[68:69], s[0:1], 96
    s_waitcnt lgkmcnt(0)
    s_mov_b32 s53, 14909440
    s_load_dword s93, s[22:23], s53
    s_mov_b32 s48, s4
    s_and_b32 s49, s5, 0xffff
    s_mov_b32 s50, 2097152
    s_mov_b32 s51, 0x00020000
    s_cmp_ge_u32 s25, 4
    s_cselect_b32 s84, s10, s8
    s_cselect_b32 s85, s11, s9
    s_and_b32 s85, s85, 0xffff
    s_mov_b32 s86, 0x80000
    s_mov_b32 s87, 0x00020000
    s_add_u32 m0, s58, 0
    s_add_u32 s62, s54, 0
    buffer_load_dwordx4 v12, s[48:51], s62 offen lds
    s_add_u32 m0, s58, 1024
    s_add_u32 s62, s54, 4096
    buffer_load_dwordx4 v13, s[48:51], s62 offen lds
    s_add_u32 m0, s56, 16384
    s_add_u32 s62, s55, 0
    buffer_load_dwordx4 v127, s[84:87], s62 offen lds
    s_mov_b32 s44, s16
    s_and_b32 s45, s17, 0xffff
    s_mov_b32 s46, 1835008
    s_mov_b32 s47, 0x00020000
    s_movk_i32 s53, 3584
    v_lshrrev_b32 v19, 2, v1
    v_mul_lo_u32 v19, v19, s53
    v_and_b32 v20, 3, v1
    v_lshl_add_u32 v19, v20, 4, v19
    s_lshl_b32 s59, s27, 5
    s_mul_i32 s59, s59, 3584
    s_lshl_b32 s60, s29, 7
    s_add_u32 s59, s59, s60
    s_lshl_b32 s60, s24, 6
    s_add_u32 s59, s59, s60
    buffer_load_dwordx4 v[96:99], v19, s[44:47], s59 offen
    s_add_u32 s59, s59, 57344
    buffer_load_dwordx4 v[100:103], v19, s[44:47], s59 offen
    s_add_u32 m0, s58, 24576
    s_add_u32 s62, s54, 128
    buffer_load_dwordx4 v12, s[48:51], s62 offen lds
    s_add_u32 m0, s58, 25600
    s_add_u32 s62, s54, 4224
    buffer_load_dwordx4 v13, s[48:51], s62 offen lds
    s_add_u32 m0, s56, 40960
    s_add_u32 s62, s55, 128
    buffer_load_dwordx4 v127, s[84:87], s62 offen lds
    s_add_u32 m0, s58, 49152
    s_add_u32 s62, s54, 256
    buffer_load_dwordx4 v12, s[48:51], s62 offen lds
    s_add_u32 m0, s58, 50176
    s_add_u32 s62, s54, 4352
    buffer_load_dwordx4 v13, s[48:51], s62 offen lds
    s_add_u32 m0, s56, 65536
    s_add_u32 s62, s55, 256
    buffer_load_dwordx4 v127, s[84:87], s62 offen lds
    s_movk_i32 s53, 3584
    v_lshrrev_b32 v14, 3, v1
    v_mul_lo_u32 v14, v14, s53
    v_bfe_u32 v15, v1, 4, 1
    v_lshlrev_b32 v15, 2, v15
    v_xor_b32 v15, v15, v1
    v_and_b32 v15, 7, v15
    v_lshl_add_u32 v14, v15, 4, v14
    s_mov_b32 s32, s22
    s_and_b32 s33, s23, 0xffff
    s_mov_b32 s34, 14911744
    s_mov_b32 s35, 0x00020000
    s_mov_b32 s36, s20
    s_and_b32 s37, s21, 0xffff
    s_mov_b32 s38, 256
    s_mov_b32 s39, 0x00020000
    s_mov_b32 s40, s18
    s_and_b32 s41, s19, 0xffff
    s_mov_b32 s42, 3584
    s_mov_b32 s43, 0x00020000
    s_waitcnt lgkmcnt(0)
    s_add_u32 s93, s93, 1
    v_bfe_u32 v15, v2, 1, 3
    v_xor_b32 v15, v15, v3
    v_lshlrev_b32 v15, 4, v15
    v_lshl_add_u32 v15, v2, 7, v15
    v_xor_b32 v4, 0, v15
    v_add_u32 v4, s52, v4
    v_xor_b32 v5, 32, v15
    v_add_u32 v5, s52, v5
    v_xor_b32 v6, 64, v15
    v_add_u32 v6, s52, v6
    v_xor_b32 v7, 96, v15
    v_add_u32 v7, s52, v7
    v_and_b32 v19, 15, v1
    v_lshrrev_b32 v20, 4, v1
    v_bfe_u32 v15, v1, 1, 3
    v_xor_b32 v20, v20, v15
    v_lshlrev_b32 v20, 4, v20
    v_lshl_add_u32 v20, v19, 7, v20
    v_add_u32 v8, s52, v20
    v_xor_b32 v9, 64, v8
    s_lshl_b32 s59, s24, 11
    s_add_u32 s59, s59, 16384
    v_add_u32 v10, s59, v20
    v_xor_b32 v11, 64, v10
    v_mov_b32 v92, 0x3f803f80
    v_mov_b32 v93, 0x3f803f80
    v_mov_b32 v94, 0x3f803f80
    v_mov_b32 v95, 0x3f803f80
    s_waitcnt vmcnt(8)
    s_barrier
    ds_read_b128 v[44:47], v8
    ds_read_b128 v[48:51], v9
    ds_read_b128 v[52:55], v8 offset:2048
    ds_read_b128 v[56:59], v9 offset:2048
    ds_read_b128 v[60:63], v10
    ds_read_b128 v[64:67], v11
    ds_read_b128 a[0:3], v4
    ds_read_b128 a[4:7], v5
    ds_read_b128 a[8:11], v6
    ds_read_b128 a[12:15], v7
    v_add_u32 v4, 24576, v4
    v_add_u32 v5, 24576, v5
    v_add_u32 v6, 24576, v6
    v_add_u32 v7, 24576, v7
    v_add_u32 v8, 24576, v8
    v_add_u32 v9, 24576, v9
    v_add_u32 v10, 24576, v10
    v_add_u32 v11, 24576, v11
    s_add_u32 m0, s58, 73728
    s_add_u32 s62, s54, 384
    buffer_load_dwordx4 v12, s[48:51], s62 offen lds
    s_add_u32 m0, s58, 74752
    s_add_u32 s62, s54, 4480
    buffer_load_dwordx4 v13, s[48:51], s62 offen lds
    s_add_u32 m0, s56, 90112
    s_add_u32 s62, s55, 384
    buffer_load_dwordx4 v127, s[84:87], s62 offen lds
    s_waitcnt vmcnt(6) lgkmcnt(0)
    s_barrier
    ds_read_b128 v[68:71], v8
    ds_read_b128 v[72:75], v9
    ds_read_b128 v[76:79], v8 offset:2048
    ds_read_b128 v[80:83], v9 offset:2048
    ds_read_b128 v[84:87], v10
    ds_read_b128 v[88:91], v11
    ds_read_b128 a[16:19], v4
    ds_read_b128 a[20:23], v5
    ds_read_b128 a[24:27], v6
    ds_read_b128 a[28:31], v7
    v_add_u32 v4, 24576, v4
    v_add_u32 v5, 24576, v5
    v_add_u32 v6, 24576, v6
    v_add_u32 v7, 24576, v7
    v_add_u32 v8, 24576, v8
    v_add_u32 v9, 24576, v9
    v_add_u32 v10, 24576, v10
    v_add_u32 v11, 24576, v11
    v_mfma_f32_16x16x32_bf16 v[24:27], v[44:47], v[44:47], 0
    v_mfma_f32_16x16x32_bf16 v[28:31], v[52:55], v[52:55], 0
    s_add_u32 m0, s58, 98304
    s_add_u32 s62, s54, 512
    buffer_load_dwordx4 v12, s[48:51], s62 offen lds
    v_mfma_f32_16x16x32_bf16 v[32:35], v[44:47], v[92:95], 0
    v_mfma_f32_16x16x32_bf16 v[36:39], v[52:55], v[92:95], 0
    s_add_u32 m0, s58, 99328
    s_add_u32 s62, s54, 4608
    buffer_load_dwordx4 v13, s[48:51], s62 offen lds
    v_mfma_f32_16x16x32_bf16 v[40:43], v[60:63], v[92:95], 0
    v_mfma_f32_16x16x32_bf16 v[24:27], v[48:51], v[48:51], v[24:27]
    s_add_u32 m0, s56, 114688
    s_add_u32 s62, s55, 512
    buffer_load_dwordx4 v127, s[84:87], s62 offen lds
    v_mfma_f32_16x16x32_bf16 v[28:31], v[56:59], v[56:59], v[28:31]
    v_mfma_f32_16x16x32_bf16 v[32:35], v[48:51], v[92:95], v[32:35]
    v_mfma_f32_16x16x32_bf16 v[36:39], v[56:59], v[92:95], v[36:39]
    v_mfma_f32_16x16x32_bf16 v[40:43], v[64:67], v[92:95], v[40:43]
    v_lshlrev_b32 v104, 16, v96
    v_and_b32 v106, 0xffff0000, v96
    v_lshlrev_b32 v15, 16, v100
    v_and_b32 v100, 0xffff0000, v100
    v_add_f32 v104, v104, v15
    v_add_f32 v106, v106, v100
    v_lshlrev_b32 v108, 16, v97
    v_and_b32 v110, 0xffff0000, v97
    v_lshlrev_b32 v15, 16, v101
    v_and_b32 v101, 0xffff0000, v101
    v_add_f32 v108, v108, v15
    v_add_f32 v110, v110, v101
    v_lshlrev_b32 v112, 16, v98
    v_and_b32 v114, 0xffff0000, v98
    v_lshlrev_b32 v15, 16, v102
    v_and_b32 v102, 0xffff0000, v102
    v_add_f32 v112, v112, v15
    v_add_f32 v114, v114, v102
    v_lshlrev_b32 v116, 16, v99
    v_and_b32 v118, 0xffff0000, v99
    v_lshlrev_b32 v15, 16, v103
    v_and_b32 v103, 0xffff0000, v103
    v_add_f32 v116, v116, v15
    v_add_f32 v118, v118, v103
    v_add_f32_dpp v104, v104, v104 row_ror:4 row_mask:0xf bank_mask:0xf
    v_add_f32_dpp v106, v106, v106 row_ror:4 row_mask:0xf bank_mask:0xf
    v_add_f32_dpp v108, v108, v108 row_ror:4 row_mask:0xf bank_mask:0xf
    v_add_f32_dpp v110, v110, v110 row_ror:4 row_mask:0xf bank_mask:0xf
    v_add_f32_dpp v112, v112, v112 row_ror:4 row_mask:0xf bank_mask:0xf
    v_add_f32_dpp v114, v114, v114 row_ror:4 row_mask:0xf bank_mask:0xf
    v_add_f32_dpp v116, v116, v116 row_ror:4 row_mask:0xf bank_mask:0xf
    v_add_f32_dpp v118, v118, v118 row_ror:4 row_mask:0xf bank_mask:0xf
    v_add_f32_dpp v104, v104, v104 row_ror:8 row_mask:0xf bank_mask:0xf
    v_add_f32_dpp v106, v106, v106 row_ror:8 row_mask:0xf bank_mask:0xf
    v_add_f32_dpp v108, v108, v108 row_ror:8 row_mask:0xf bank_mask:0xf
    v_add_f32_dpp v110, v110, v110 row_ror:8 row_mask:0xf bank_mask:0xf
    v_add_f32_dpp v112, v112, v112 row_ror:8 row_mask:0xf bank_mask:0xf
    v_add_f32_dpp v114, v114, v114 row_ror:8 row_mask:0xf bank_mask:0xf
    v_add_f32_dpp v116, v116, v116 row_ror:8 row_mask:0xf bank_mask:0xf
    v_add_f32_dpp v118, v118, v118 row_ror:8 row_mask:0xf bank_mask:0xf
    v_mov_b32 v96, v104
    v_mov_b32 v97, v106
    v_mov_b32 v98, v108
    v_mov_b32 v99, v110
    v_mov_b32 v100, v112
    v_mov_b32 v101, v114
    v_mov_b32 v102, v116
    v_mov_b32 v103, v118
    v_permlane16_swap_b32 v104, v96
    v_permlane16_swap_b32 v106, v97
    v_permlane16_swap_b32 v108, v98
    v_permlane16_swap_b32 v110, v99
    v_permlane16_swap_b32 v112, v100
    v_permlane16_swap_b32 v114, v101
    v_permlane16_swap_b32 v116, v102
    v_permlane16_swap_b32 v118, v103
    v_add_f32 v104, v104, v96
    v_add_f32 v106, v106, v97
    v_add_f32 v108, v108, v98
    v_add_f32 v110, v110, v99
    v_add_f32 v112, v112, v100
    v_add_f32 v114, v114, v101
    v_add_f32 v116, v116, v102
    v_add_f32 v118, v118, v103
    v_mov_b32 v96, v104
    v_mov_b32 v97, v106
    v_mov_b32 v98, v108
    v_mov_b32 v99, v110
    v_mov_b32 v100, v112
    v_mov_b32 v101, v114
    v_mov_b32 v102, v116
    v_mov_b32 v103, v118
    v_permlane32_swap_b32 v104, v96
    v_permlane32_swap_b32 v106, v97
    v_permlane32_swap_b32 v108, v98
    v_permlane32_swap_b32 v110, v99
    v_permlane32_swap_b32 v112, v100
    v_permlane32_swap_b32 v114, v101
    v_permlane32_swap_b32 v116, v102
    v_permlane32_swap_b32 v118, v103
    v_add_f32 v104, v104, v96
    v_add_f32 v106, v106, v97
    v_add_f32 v108, v108, v98
    v_add_f32 v110, v110, v99
    v_add_f32 v112, v112, v100
    v_add_f32 v114, v114, v101
    v_add_f32 v116, v116, v102
    v_add_f32 v118, v118, v103
    v_mov_b32 v105, s93
    v_mov_b32 v107, s93
    v_mov_b32 v109, s93
    v_mov_b32 v111, s93
    v_mov_b32 v113, s93
    v_mov_b32 v115, s93
    v_mov_b32 v117, s93
    v_mov_b32 v119, s93
    s_lshl_b32 s59, s28, 4
    s_add_u32 s59, s59, s27
    s_lshl_b32 s60, s59, 10
    s_lshl_b32 s59, s24, 8
    s_add_u32 s60, s60, s59
    s_add_u32 s60, s60, 14516224
    v_and_b32 v15, 3, v1
    v_lshlrev_b32 v15, 6, v15
    s_mov_b64 exec, 0xf
    buffer_store_dwordx4 v[104:107], v15, s[32:35], s60 offen offset:0 sc1
    buffer_store_dwordx4 v[108:111], v15, s[32:35], s60 offen offset:16 sc1
    buffer_store_dwordx4 v[112:115], v15, s[32:35], s60 offen offset:32 sc1
    buffer_store_dwordx4 v[116:119], v15, s[32:35], s60 offen offset:48 sc1
    s_mov_b64 exec, -1
    s_waitcnt vmcnt(10) lgkmcnt(0)
    s_barrier
    ds_read_b128 v[44:47], v8
    ds_read_b128 v[48:51], v9
    ds_read_b128 v[52:55], v8 offset:2048
    ds_read_b128 v[56:59], v9 offset:2048
    ds_read_b128 v[60:63], v10
    ds_read_b128 v[64:67], v11
    ds_read_b128 a[32:35], v4
    ds_read_b128 a[36:39], v5
    ds_read_b128 a[40:43], v6
    ds_read_b128 a[44:47], v7
    v_add_u32 v4, 24576, v4
    v_add_u32 v5, 24576, v5
    v_add_u32 v6, 24576, v6
    v_add_u32 v7, 24576, v7
    v_add_u32 v8, 24576, v8
    v_add_u32 v9, 24576, v9
    v_add_u32 v10, 24576, v10
    v_add_u32 v11, 24576, v11
    v_mfma_f32_16x16x32_bf16 v[24:27], v[68:71], v[68:71], v[24:27]
    v_mfma_f32_16x16x32_bf16 v[28:31], v[76:79], v[76:79], v[28:31]
    s_add_u32 m0, s58, 122880
    s_add_u32 s62, s54, 640
    buffer_load_dwordx4 v12, s[48:51], s62 offen lds
    v_mfma_f32_16x16x32_bf16 v[32:35], v[68:71], v[92:95], v[32:35]
    v_mfma_f32_16x16x32_bf16 v[36:39], v[76:79], v[92:95], v[36:39]
    s_add_u32 m0, s58, 123904
    s_add_u32 s62, s54, 4736
    buffer_load_dwordx4 v13, s[48:51], s62 offen lds
    v_mfma_f32_16x16x32_bf16 v[40:43], v[84:87], v[92:95], v[40:43]
    v_mfma_f32_16x16x32_bf16 v[24:27], v[72:75], v[72:75], v[24:27]
    s_add_u32 m0, s56, 139264
    s_add_u32 s62, s55, 640
    buffer_load_dwordx4 v127, s[84:87], s62 offen lds
    v_mfma_f32_16x16x32_bf16 v[28:31], v[80:83], v[80:83], v[28:31]
    v_mfma_f32_16x16x32_bf16 v[32:35], v[72:75], v[92:95], v[32:35]
    v_mfma_f32_16x16x32_bf16 v[36:39], v[80:83], v[92:95], v[36:39]
    v_mfma_f32_16x16x32_bf16 v[40:43], v[88:91], v[92:95], v[40:43]
    s_waitcnt vmcnt(10) lgkmcnt(0)
    s_barrier
    ds_read_b128 v[68:71], v8
    ds_read_b128 v[72:75], v9
    ds_read_b128 v[76:79], v8 offset:2048
    ds_read_b128 v[80:83], v9 offset:2048
    ds_read_b128 v[84:87], v10
    ds_read_b128 v[88:91], v11
    ds_read_b128 a[48:51], v4
    ds_read_b128 a[52:55], v5
    ds_read_b128 a[56:59], v6
    ds_read_b128 a[60:63], v7
    v_add_u32 v4, 24576, v4
    v_add_u32 v5, 24576, v5
    v_add_u32 v6, 24576, v6
    v_add_u32 v7, 24576, v7
    v_add_u32 v8, 24576, v8
    v_add_u32 v9, 24576, v9
    v_add_u32 v10, 24576, v10
    v_add_u32 v11, 24576, v11
    v_mfma_f32_16x16x32_bf16 v[24:27], v[44:47], v[44:47], v[24:27]
    v_mfma_f32_16x16x32_bf16 v[28:31], v[52:55], v[52:55], v[28:31]
    s_add_u32 m0, s58, 0
    s_add_u32 s62, s54, 768
    buffer_load_dwordx4 v12, s[48:51], s62 offen lds
    v_mfma_f32_16x16x32_bf16 v[32:35], v[44:47], v[92:95], v[32:35]
    v_mfma_f32_16x16x32_bf16 v[36:39], v[52:55], v[92:95], v[36:39]
    s_add_u32 m0, s58, 1024
    s_add_u32 s62, s54, 4864
    buffer_load_dwordx4 v13, s[48:51], s62 offen lds
    v_mfma_f32_16x16x32_bf16 v[40:43], v[60:63], v[92:95], v[40:43]
    v_mfma_f32_16x16x32_bf16 v[24:27], v[48:51], v[48:51], v[24:27]
    s_add_u32 m0, s56, 16384
    s_add_u32 s62, s55, 768
    buffer_load_dwordx4 v127, s[84:87], s62 offen lds
    v_mfma_f32_16x16x32_bf16 v[28:31], v[56:59], v[56:59], v[28:31]
    v_mfma_f32_16x16x32_bf16 v[32:35], v[48:51], v[92:95], v[32:35]
    v_mfma_f32_16x16x32_bf16 v[36:39], v[56:59], v[92:95], v[36:39]
    v_mfma_f32_16x16x32_bf16 v[40:43], v[64:67], v[92:95], v[40:43]
    s_waitcnt vmcnt(10) lgkmcnt(0)
    s_barrier
    ds_read_b128 v[44:47], v8
    ds_read_b128 v[48:51], v9
    ds_read_b128 v[52:55], v8 offset:2048
    ds_read_b128 v[56:59], v9 offset:2048
    ds_read_b128 v[60:63], v10
    ds_read_b128 v[64:67], v11
    ds_read_b128 a[64:67], v4
    ds_read_b128 a[68:71], v5
    ds_read_b128 a[72:75], v6
    ds_read_b128 a[76:79], v7
    v_add_u32 v4, 24576, v4
    v_add_u32 v5, 24576, v5
    v_add_u32 v6, 24576, v6
    v_add_u32 v7, 24576, v7
    v_add_u32 v8, 24576, v8
    v_add_u32 v9, 24576, v9
    v_add_u32 v10, 24576, v10
    v_add_u32 v11, 24576, v11
    v_mfma_f32_16x16x32_bf16 v[24:27], v[68:71], v[68:71], v[24:27]
    v_mfma_f32_16x16x32_bf16 v[28:31], v[76:79], v[76:79], v[28:31]
    s_add_u32 m0, s58, 24576
    s_add_u32 s62, s54, 896
    buffer_load_dwordx4 v12, s[48:51], s62 offen lds
    v_mfma_f32_16x16x32_bf16 v[32:35], v[68:71], v[92:95], v[32:35]
    v_mfma_f32_16x16x32_bf16 v[36:39], v[76:79], v[92:95], v[36:39]
    s_add_u32 m0, s58, 25600
    s_add_u32 s62, s54, 4992
    buffer_load_dwordx4 v13, s[48:51], s62 offen lds
    v_mfma_f32_16x16x32_bf16 v[40:43], v[84:87], v[92:95], v[40:43]
    v_mfma_f32_16x16x32_bf16 v[24:27], v[72:75], v[72:75], v[24:27]
    s_add_u32 m0, s56, 40960
    s_add_u32 s62, s55, 896
    buffer_load_dwordx4 v127, s[84:87], s62 offen lds
    v_mfma_f32_16x16x32_bf16 v[28:31], v[80:83], v[80:83], v[28:31]
    v_mfma_f32_16x16x32_bf16 v[32:35], v[72:75], v[92:95], v[32:35]
    v_mfma_f32_16x16x32_bf16 v[36:39], v[80:83], v[92:95], v[36:39]
    v_mfma_f32_16x16x32_bf16 v[40:43], v[88:91], v[92:95], v[40:43]
    s_waitcnt vmcnt(6) lgkmcnt(0)
    s_barrier
    ds_read_b128 v[68:71], v8
    ds_read_b128 v[72:75], v9
    ds_read_b128 v[76:79], v8 offset:2048
    ds_read_b128 v[80:83], v9 offset:2048
    ds_read_b128 v[84:87], v10
    ds_read_b128 v[88:91], v11
    ds_read_b128 a[80:83], v4
    ds_read_b128 a[84:87], v5
    ds_read_b128 a[88:91], v6
    ds_read_b128 a[92:95], v7
    v_subrev_u32 v4, 122880, v4
    v_subrev_u32 v5, 122880, v5
    v_subrev_u32 v6, 122880, v6
    v_subrev_u32 v7, 122880, v7
    v_subrev_u32 v8, 122880, v8
    v_subrev_u32 v9, 122880, v9
    v_subrev_u32 v10, 122880, v10
    v_subrev_u32 v11, 122880, v11
    v_mfma_f32_16x16x32_bf16 v[24:27], v[44:47], v[44:47], v[24:27]
    v_mfma_f32_16x16x32_bf16 v[28:31], v[52:55], v[52:55], v[28:31]
    s_add_u32 m0, s56, 49152
    s_add_u32 s62, s57, 0
    buffer_load_dwordx4 v14, s[44:47], s62 offen lds
    v_mfma_f32_16x16x32_bf16 v[32:35], v[44:47], v[92:95], v[32:35]
    v_mfma_f32_16x16x32_bf16 v[36:39], v[52:55], v[92:95], v[36:39]
    s_add_u32 m0, s56, 57344
    s_add_u32 s62, s57, 229376
    buffer_load_dwordx4 v14, s[44:47], s62 offen lds
    v_mfma_f32_16x16x32_bf16 v[40:43], v[60:63], v[92:95], v[40:43]
    v_mfma_f32_16x16x32_bf16 v[24:27], v[48:51], v[48:51], v[24:27]
    s_add_u32 m0, s56, 65536
    s_add_u32 s62, s57, 458752
    buffer_load_dwordx4 v14, s[44:47], s62 offen lds
    v_mfma_f32_16x16x32_bf16 v[28:31], v[56:59], v[56:59], v[28:31]
    v_mfma_f32_16x16x32_bf16 v[32:35], v[48:51], v[92:95], v[32:35]
    v_mfma_f32_16x16x32_bf16 v[36:39], v[56:59], v[92:95], v[36:39]
    v_mfma_f32_16x16x32_bf16 v[40:43], v[64:67], v[92:95], v[40:43]
    s_waitcnt vmcnt(6) lgkmcnt(0)
    s_barrier
    ds_read_b128 v[44:47], v8
    ds_read_b128 v[48:51], v9
    ds_read_b128 v[52:55], v8 offset:2048
    ds_read_b128 v[56:59], v9 offset:2048
    ds_read_b128 v[60:63], v10
    ds_read_b128 v[64:67], v11
    ds_read_b128 a[96:99], v4
    ds_read_b128 a[100:103], v5
    ds_read_b128 a[104:107], v6
    ds_read_b128 a[108:111], v7
    v_add_u32 v4, 24576, v4
    v_add_u32 v5, 24576, v5
    v_add_u32 v6, 24576, v6
    v_add_u32 v7, 24576, v7
    v_add_u32 v8, 24576, v8
    v_add_u32 v9, 24576, v9
    v_add_u32 v10, 24576, v10
    v_add_u32 v11, 24576, v11
    v_lshrrev_b32 v19, 4, v1
    v_and_b32 v20, 15, v1
    v_lshlrev_b32 v21, 10, v19
    v_lshl_add_u32 v21, v20, 4, v21
    s_lshl_b32 s59, s28, 14
    s_lshl_b32 s60, s24, 8
    s_add_u32 s59, s59, s60
    s_add_u32 s59, s59, 14516224
    buffer_load_dwordx4 v[104:107], v21, s[32:35], s59 offen sc1
    s_add_u32 s59, s59, 4096
    buffer_load_dwordx4 v[108:111], v21, s[32:35], s59 offen sc1
    s_add_u32 s59, s59, 4096
    buffer_load_dwordx4 v[112:115], v21, s[32:35], s59 offen sc1
    s_add_u32 s59, s59, 4096
    buffer_load_dwordx4 v[116:119], v21, s[32:35], s59 offen sc1
    s_add_u32 s59, s59, 4096
    s_lshl_b32 s59, s29, 7
    s_lshl_b32 s60, s24, 6
    s_add_u32 s59, s59, s60
    v_and_b32 v21, 15, v1
    v_lshlrev_b32 v21, 2, v21
    buffer_load_dword v120, v21, s[40:43], s59 offen
    v_mfma_f32_16x16x32_bf16 v[24:27], v[68:71], v[68:71], v[24:27]
    v_mfma_f32_16x16x32_bf16 v[28:31], v[76:79], v[76:79], v[28:31]
    s_add_u32 m0, s56, 73728
    s_add_u32 s62, s57, 688128
    buffer_load_dwordx4 v14, s[44:47], s62 offen lds
    v_mfma_f32_16x16x32_bf16 v[32:35], v[68:71], v[92:95], v[32:35]
    v_mfma_f32_16x16x32_bf16 v[36:39], v[76:79], v[92:95], v[36:39]
    s_add_u32 m0, s56, 81920
    s_add_u32 s62, s57, 917504
    buffer_load_dwordx4 v14, s[44:47], s62 offen lds
    v_mfma_f32_16x16x32_bf16 v[40:43], v[84:87], v[92:95], v[40:43]
    v_mfma_f32_16x16x32_bf16 v[24:27], v[72:75], v[72:75], v[24:27]
    s_add_u32 m0, s56, 90112
    s_add_u32 s62, s57, 1146880
    buffer_load_dwordx4 v14, s[44:47], s62 offen lds
    v_mfma_f32_16x16x32_bf16 v[28:31], v[80:83], v[80:83], v[28:31]
    v_mfma_f32_16x16x32_bf16 v[32:35], v[72:75], v[92:95], v[32:35]
    v_mfma_f32_16x16x32_bf16 v[36:39], v[80:83], v[92:95], v[36:39]
    v_mfma_f32_16x16x32_bf16 v[40:43], v[88:91], v[92:95], v[40:43]
    s_waitcnt vmcnt(11) lgkmcnt(0)
    s_barrier
    ds_read_b128 v[68:71], v8
    ds_read_b128 v[72:75], v9
    ds_read_b128 v[76:79], v8 offset:2048
    ds_read_b128 v[80:83], v9 offset:2048
    ds_read_b128 v[84:87], v10
    ds_read_b128 v[88:91], v11
    ds_read_b128 a[112:115], v4
    ds_read_b128 a[116:119], v5
    ds_read_b128 a[120:123], v6
    ds_read_b128 a[124:127], v7
    v_mfma_f32_16x16x32_bf16 v[24:27], v[44:47], v[44:47], v[24:27]
    v_mfma_f32_16x16x32_bf16 v[28:31], v[52:55], v[52:55], v[28:31]
    s_add_u32 m0, s56, 98304
    s_add_u32 s62, s57, 1376256
    buffer_load_dwordx4 v14, s[44:47], s62 offen lds
    v_mfma_f32_16x16x32_bf16 v[32:35], v[44:47], v[92:95], v[32:35]
    v_mfma_f32_16x16x32_bf16 v[36:39], v[52:55], v[92:95], v[36:39]
    s_add_u32 m0, s56, 106496
    s_add_u32 s62, s57, 1605632
    buffer_load_dwordx4 v14, s[44:47], s62 offen lds
    v_mfma_f32_16x16x32_bf16 v[40:43], v[60:63], v[92:95], v[40:43]
    v_mfma_f32_16x16x32_bf16 v[24:27], v[48:51], v[48:51], v[24:27]
    v_mfma_f32_16x16x32_bf16 v[28:31], v[56:59], v[56:59], v[28:31]
    v_mfma_f32_16x16x32_bf16 v[32:35], v[48:51], v[92:95], v[32:35]
    v_mfma_f32_16x16x32_bf16 v[36:39], v[56:59], v[92:95], v[36:39]
    v_mfma_f32_16x16x32_bf16 v[40:43], v[64:67], v[92:95], v[40:43]
    s_waitcnt lgkmcnt(9)
    v_mfma_f32_16x16x32_bf16 v[24:27], v[68:71], v[68:71], v[24:27]
    s_waitcnt lgkmcnt(7)
    v_mfma_f32_16x16x32_bf16 v[28:31], v[76:79], v[76:79], v[28:31]
    v_mfma_f32_16x16x32_bf16 v[32:35], v[68:71], v[92:95], v[32:35]
    v_mfma_f32_16x16x32_bf16 v[36:39], v[76:79], v[92:95], v[36:39]
    s_waitcnt lgkmcnt(5)
    v_mfma_f32_16x16x32_bf16 v[40:43], v[84:87], v[92:95], v[40:43]
    v_mfma_f32_16x16x32_bf16 v[24:27], v[72:75], v[72:75], v[24:27]
    v_mfma_f32_16x16x32_bf16 v[28:31], v[80:83], v[80:83], v[28:31]
    v_mfma_f32_16x16x32_bf16 v[32:35], v[72:75], v[92:95], v[32:35]
    v_mfma_f32_16x16x32_bf16 v[36:39], v[80:83], v[92:95], v[36:39]
    s_waitcnt lgkmcnt(4)
    v_mfma_f32_16x16x32_bf16 v[40:43], v[88:91], v[92:95], v[40:43]
    v_and_b32 v19, 3, v1
    v_cmp_eq_u32 s[76:77], 1, v19
    v_cmp_eq_u32 s[78:79], 2, v19
    v_cmp_eq_u32 s[82:83], 3, v19
    v_cndmask_b32 v96, v24, v25, s[76:77]
    v_cndmask_b32 v96, v96, v26, s[78:79]
    v_cndmask_b32 v96, v96, v27, s[82:83]
    v_cndmask_b32 v97, v28, v29, s[76:77]
    v_cndmask_b32 v97, v97, v30, s[78:79]
    v_cndmask_b32 v97, v97, v31, s[82:83]
    v_cndmask_b32 v98, v32, v33, s[76:77]
    v_cndmask_b32 v98, v98, v34, s[78:79]
    v_cndmask_b32 v98, v98, v35, s[82:83]
    v_cndmask_b32 v99, v36, v37, s[76:77]
    v_cndmask_b32 v99, v99, v38, s[78:79]
    v_cndmask_b32 v99, v99, v39, s[82:83]
    v_mul_f32 v98, 0x3b000000, v98
    v_mul_f32 v96, 0x3b000000, v96
    v_fma_f32 v96, -v98, v98, v96
    v_max_f32 v96, 0, v96
    v_cvt_pk_bf16_f32 v98, v98, v96
    v_and_b32 v96, 0xffff0000, v98
    v_lshlrev_b32 v98, 16, v98
    v_add_f32 v96, 0x3727c5ac, v96
    v_cvt_pk_bf16_f32 v96, v96, v96
    v_and_b32 v96, 0xffff0000, v96
    v_sqrt_f32 v96, v96
    s_nop 0
    v_cvt_pk_bf16_f32 v96, v96, v96
    v_and_b32 v96, 0xffff0000, v96
    v_rcp_f32 v100, v96
    v_mul_f32 v99, 0x3b000000, v99
    v_mul_f32 v97, 0x3b000000, v97
    v_fma_f32 v97, -v99, v99, v97
    v_max_f32 v97, 0, v97
    v_cvt_pk_bf16_f32 v99, v99, v97
    v_and_b32 v97, 0xffff0000, v99
    v_lshlrev_b32 v99, 16, v99
    v_add_f32 v97, 0x3727c5ac, v97
    v_cvt_pk_bf16_f32 v97, v97, v97
    v_and_b32 v97, 0xffff0000, v97
    v_sqrt_f32 v97, v97
    s_nop 0
    v_cvt_pk_bf16_f32 v97, v97, v97
    v_and_b32 v97, 0xffff0000, v97
    v_rcp_f32 v101, v97
    v_lshrrev_b32 v19, 4, v1
    v_bfe_u32 v20, v1, 2, 2
    v_cmp_eq_u32 vcc, v19, v20
    s_nop 2
    s_and_saveexec_b64 s[70:71], vcc
    v_and_b32 v19, 15, v1
    s_lshl_b32 s59, s24, 8
    s_add_u32 s59, s59, 16384
    v_lshlrev_b32 v20, 3, v19
    v_add_u32 v20, s59, v20
    v_mov_b32 v16, v98
    v_mov_b32 v17, v96
    v_mov_b32 v22, v99
    v_mov_b32 v23, v97
    ds_write_b64 v20, v[16:17]
    ds_write_b64 v20, v[22:23] offset:128
    s_nop 1
    v_bfe_u32 v20, v19, 2, 1
    v_lshlrev_b32 v20, 4, v20
    v_lshrrev_b32 v21, 3, v19
    v_lshl_add_u32 v20, v21, 2, v20
    v_and_b32 v21, 3, v19
    v_add_u32 v20, v20, v21
    s_lshl_b32 s59, s24, 7
    s_add_u32 s59, s59, 17408
    v_lshlrev_b32 v21, 2, v20
    v_add_u32 v21, s59, v21
    ds_write_b32 v21, v100
    ds_write_b32 v21, v101 offset:32
    s_cmp_lg_u32 s28, 0
    s_cbranch_scc1 parallel_sum__ssm_conv_s5__dense_activation_gelu__prompt_kernel_nogst
    v_mov_b32 v17, v100
    v_mov_b32 v23, v101
    s_lshl_b32 s59, s27, 10
    s_lshl_b32 s60, s24, 8
    s_add_u32 s59, s59, s60
    s_add_u32 s59, s59, 14417920
    v_lshlrev_b32 v21, 3, v20
    buffer_store_dwordx2 v[16:17], v21, s[32:35], s59 offen sc0 sc1
    buffer_store_dwordx2 v[22:23], v21, s[32:35], s59 offen offset:64 sc0 sc1
parallel_sum__ssm_conv_s5__dense_activation_gelu__prompt_kernel_nogst:
    s_mov_b64 exec, s[70:71]
    v_and_b32 v19, 15, v1
    v_cmp_eq_u32 vcc, 0, v19
    s_nop 2
    s_and_saveexec_b64 s[70:71], vcc
    v_and_b32 v19, 48, v1
    s_lshl_b32 s59, s24, 6
    s_add_u32 s59, s59, 17920
    v_add_u32 v19, s59, v19
    ds_write_b128 v19, v[40:43]
    s_mov_b64 exec, s[70:71]
    s_waitcnt vmcnt(0) lgkmcnt(0)
    s_barrier
    s_cmp_eq_u32 s30, 3
    s_cbranch_scc1 parallel_sum__ssm_conv_s5__dense_activation_gelu__prompt_kernel_lightB
    s_lshl_b32 s56, s24, 14
    s_add_u32 s56, s56, 114688
    s_cmp_eq_u32 s24, 3
    s_cselect_b32 s56, 0, s56
    s_mul_i32 s57, s24, 458752
    s_lshl_b32 s53, s29, 7
    s_add_u32 s57, s57, s53
    s_add_u32 s57, s57, 128
    v_mov_b32 v121, v14
    s_add_u32 m0, s56, 0
    s_add_u32 s62, s57, 0
    buffer_load_dwordx4 v121, s[44:47], s62 offen lds
    s_add_u32 m0, s56, 1024
    s_add_u32 s62, s57, 28672
    buffer_load_dwordx4 v121, s[44:47], s62 offen lds
    s_add_u32 m0, s56, 2048
    s_add_u32 s62, s57, 57344
    buffer_load_dwordx4 v121, s[44:47], s62 offen lds
    s_add_u32 m0, s56, 3072
    s_add_u32 s62, s57, 86016
    buffer_load_dwordx4 v121, s[44:47], s62 offen lds
    s_mov_b32 s62, 0
parallel_sum__ssm_conv_s5__dense_activation_gelu__prompt_kernel_h_cchk:
    v_xor_b32 v105, s93, v105
    v_xor_b32 v107, s93, v107
    v_xor_b32 v109, s93, v109
    v_xor_b32 v111, s93, v111
    v_xor_b32 v113, s93, v113
    v_xor_b32 v115, s93, v115
    v_xor_b32 v117, s93, v117
    v_xor_b32 v119, s93, v119
    v_or3_b32 v24, v105, v107, v109
    v_or3_b32 v25, v111, v113, v115
    v_or3_b32 v24, v24, v117, v119
    v_or_b32 v24, v24, v25
    v_cmp_ne_u32 s[96:97], 0, v24
    s_nop 2
    s_cmp_eq_u64 s[96:97], 0
    s_cbranch_scc1 parallel_sum__ssm_conv_s5__dense_activation_gelu__prompt_kernel_h_cok
    s_add_u32 s62, s62, 1
    s_cmp_gt_u32 s62, 100000
    s_cbranch_scc1 parallel_sum__ssm_conv_s5__dense_activation_gelu__prompt_kernel_h_cok
    s_sleep 2
    v_lshrrev_b32 v19, 4, v1
    v_and_b32 v20, 15, v1
    v_lshlrev_b32 v21, 10, v19
    v_lshl_add_u32 v21, v20, 4, v21
    s_lshl_b32 s59, s28, 14
    s_lshl_b32 s60, s24, 8
    s_add_u32 s59, s59, s60
    s_add_u32 s59, s59, 14516224
    buffer_load_dwordx4 v[104:107], v21, s[32:35], s59 offen sc1
    s_add_u32 s59, s59, 4096
    buffer_load_dwordx4 v[108:111], v21, s[32:35], s59 offen sc1
    s_add_u32 s59, s59, 4096
    buffer_load_dwordx4 v[112:115], v21, s[32:35], s59 offen sc1
    s_add_u32 s59, s59, 4096
    buffer_load_dwordx4 v[116:119], v21, s[32:35], s59 offen sc1
    s_add_u32 s59, s59, 4096
    s_waitcnt vmcnt(0)
    s_branch parallel_sum__ssm_conv_s5__dense_activation_gelu__prompt_kernel_h_cchk
parallel_sum__ssm_conv_s5__dense_activation_gelu__prompt_kernel_h_cok:
    v_add_f32 v24, v104, v108
    v_add_f32 v25, v106, v110
    v_add_f32 v26, v112, v116
    v_add_f32 v27, v114, v118
    v_add_f32 v24, v24, v26
    v_add_f32 v25, v25, v27
    v_mov_b32 v29, v120
    s_lshl_b32 s54, s31, 8
    s_add_u32 s54, s54, 16384
    v_lshlrev_b32 v12, 3, v2
    v_add_u32 v12, s54, v12
    ds_read_b64 v[110:111], v12
    v_bfe_u32 v13, v1, 2, 2
    v_lshl_add_u32 v14, v3, 3, v13
    v_lshlrev_b32 v14, 7, v14
    v_bfe_u32 v15, v1, 4, 1
    v_lshlrev_b32 v15, 1, v15
    v_bfe_u32 v12, v1, 1, 1
    v_add_u32 v15, v15, v12
    v_lshrrev_b32 v12, 1, v13
    v_lshl_add_u32 v15, v12, 2, v15
    v_lshl_add_u32 v14, v15, 4, v14
    v_and_b32 v12, 1, v1
    v_lshl_add_u32 v8, v12, 3, v14
    v_xor_b32 v11, 64, v8
    v_add_u32 v4, 49152, v8
    v_add_u32 v5, 49152, v11
    v_add_u32 v6, 114688, v8
    v_add_u32 v7, 114688, v11
    v_lshlrev_b32 v9, 4, v1
    v_mov_b32 v104, 0
    v_mov_b32 v105, 0
    v_mov_b32 v106, 0
    v_mov_b32 v107, 0
    s_waitcnt lgkmcnt(0)
    v_rcp_f32 v108, v111
    s_mov_b32 exec_hi, 0
    v_cvt_pk_bf16_f32 v104, -v110, -v110
    v_lshrrev_b32 v105, 16, v111
    s_mov_b32 exec_hi, -1
    v_mul_f32 v109, v108, v108
    v_mul_f32 v109, v109, v108
    v_mul_f32 v109, 0xbdd2d3e8, v109
    v_mul_f32 v108, 0xc0135761, v108
    v_mov_b32 v110, v111
    s_lshl_b32 s60, s27, 1
    s_lshr_b32 s61, s31, 1
    s_add_u32 s60, s60, s61
    s_mul_i32 s60, s60, 360448
    s_and_b32 s61, s31, 1
    s_lshl_b32 s61, s61, 10
    s_add_u32 s60, s60, s61
    s_add_u32 s60, s60, 0
    v_lshlrev_b32 v10, 3, v2
    v_add_u32 v10, 20480, v10
    s_mov_b32 exec_lo, 0
    v_mov_b32 v10, 21760
    s_mov_b32 exec_lo, -1
    v_mov_b32 v102, 0
    v_mov_b32 v103, 0
    s_lshl_b32 s63, s29, 13
    s_add_u32 s63, s63, s60
    s_add_u32 s63, s63, 131072
    ds_read_b64_tr_b16 v[80:81], v4 offset:0
    ds_read_b64_tr_b16 v[82:83], v4 offset:512
    ds_read_b64_tr_b16 v[84:85], v4 offset:2048
    ds_read_b64_tr_b16 v[86:87], v4 offset:2560
    ds_read_b64_tr_b16 v[88:89], v4 offset:4096
    ds_read_b64_tr_b16 v[90:91], v4 offset:4608
    ds_read_b64_tr_b16 v[92:93], v4 offset:6144
    ds_read_b64_tr_b16 v[94:95], v4 offset:6656
    ds_read_b64_tr_b16 v[96:97], v4 offset:8192
    ds_read_b64_tr_b16 v[98:99], v4 offset:8704
    s_waitcnt lgkmcnt(8)
    v_mfma_f32_32x32x16_bf16 v[48:63], v[80:83], a[0:3], 0
    v_mov_b32 v26, v24
    v_mov_b32 v27, v25
    ds_read_b64_tr_b16 v[80:81], v4 offset:10240
    ds_read_b64_tr_b16 v[82:83], v4 offset:10752
    s_waitcnt lgkmcnt(8)
    v_mfma_f32_32x32x16_bf16 v[48:63], v[84:87], a[4:7], v[48:63]
    v_permlane16_swap_b32 v24, v26
    v_permlane16_swap_b32 v25, v27
    s_barrier
    ds_read_b64_tr_b16 v[84:85], v4 offset:12288
    ds_read_b64_tr_b16 v[86:87], v4 offset:12800
    s_waitcnt lgkmcnt(8)
    v_mfma_f32_32x32x16_bf16 v[48:63], v[88:91], a[8:11], v[48:63]
    v_add_f32 v24, v24, v26
    v_add_f32 v25, v25, v27
    v_mov_b32 v26, v24
    ds_read_b64_tr_b16 v[88:89], v4 offset:14336
    ds_read_b64_tr_b16 v[90:91], v4 offset:14848
    s_waitcnt lgkmcnt(8)
    v_mfma_f32_32x32x16_bf16 v[48:63], v[92:95], a[12:15], v[48:63]
    v_mov_b32 v27, v25
    v_permlane32_swap_b32 v24, v26
    s_nop 0
    v_permlane32_swap_b32 v25, v27
    ds_read_b64_tr_b16 v[92:93], v4 offset:16384
    ds_read_b64_tr_b16 v[94:95], v4 offset:16896
    s_waitcnt lgkmcnt(8)
    v_mfma_f32_32x32x16_bf16 v[48:63], v[96:99], a[16:19], v[48:63]
    v_add_f32 v24, v24, v26
    v_add_f32 v25, v25, v27
    v_cvt_pk_bf16_f32 v26, v24, v24
    ds_read_b64_tr_b16 v[96:97], v4 offset:18432
    ds_read_b64_tr_b16 v[98:99], v4 offset:18944
    s_waitcnt lgkmcnt(8)
    v_mfma_f32_32x32x16_bf16 v[48:63], v[80:83], a[20:23], v[48:63]
    v_and_b32 v26, 0xffff0000, v26
    v_sub_f32 v26, v24, v26
    v_cvt_pk_bf16_f32 v16, v24, v26
    ds_read_b64_tr_b16 v[80:81], v4 offset:20480
    ds_read_b64_tr_b16 v[82:83], v4 offset:20992
    s_waitcnt lgkmcnt(8)
    v_mfma_f32_32x32x16_bf16 v[48:63], v[84:87], a[24:27], v[48:63]
    v_cvt_pk_bf16_f32 v26, v25, v25
    v_and_b32 v26, 0xffff0000, v26
    v_sub_f32 v26, v25, v26
    ds_read_b64_tr_b16 v[84:85], v4 offset:22528
    ds_read_b64_tr_b16 v[86:87], v4 offset:23040
    s_waitcnt lgkmcnt(8)
    v_mfma_f32_32x32x16_bf16 v[48:63], v[88:91], a[28:31], v[48:63]
    v_cvt_pk_bf16_f32 v18, v25, v26
    v_and_b32 v17, 0xffff, v29
    v_lshrrev_b32 v19, 16, v29
    ds_read_b64_tr_b16 v[88:89], v4 offset:24576
    ds_read_b64_tr_b16 v[90:91], v4 offset:25088
    s_waitcnt lgkmcnt(8)
    v_mfma_f32_32x32x16_bf16 v[48:63], v[92:95], a[32:35], v[48:63]
    v_and_b32 v28, 15, v1
    v_lshlrev_b32 v28, 4, v28
    s_lshl_b32 s59, s24, 8
    ds_read_b64_tr_b16 v[92:93], v4 offset:26624
    ds_read_b64_tr_b16 v[94:95], v4 offset:27136
    s_waitcnt lgkmcnt(8)
    v_mfma_f32_32x32x16_bf16 v[48:63], v[96:99], a[36:39], v[48:63]
    s_add_u32 s59, s59, 20480
    v_add_u32 v28, s59, v28
    s_mov_b64 exec, 0xffff
    ds_write_b128 v28, v[16:19]
    s_mov_b64 exec, -1
    ds_read_b64_tr_b16 v[96:97], v4 offset:28672
    ds_read_b64_tr_b16 v[98:99], v4 offset:29184
    s_waitcnt lgkmcnt(9)
    v_mfma_f32_32x32x16_bf16 v[48:63], v[80:83], a[40:43], v[48:63]
    ds_read_b64_tr_b16 v[80:81], v4 offset:30720
    ds_read_b64_tr_b16 v[82:83], v4 offset:31232
    s_waitcnt lgkmcnt(9)
    v_mfma_f32_32x32x16_bf16 v[48:63], v[84:87], a[44:47], v[48:63]
    ds_read_b64_tr_b16 v[84:85], v4 offset:32768
    ds_read_b64_tr_b16 v[86:87], v4 offset:33280
    s_waitcnt lgkmcnt(9)
    v_mfma_f32_32x32x16_bf16 v[48:63], v[88:91], a[48:51], v[48:63]
    s_add_u32 m0, s56, 4096
    s_add_u32 s62, s57, 114688
    buffer_load_dwordx4 v121, s[44:47], s62 offen lds
    ds_read_b64_tr_b16 v[88:89], v4 offset:34816
    ds_read_b64_tr_b16 v[90:91], v4 offset:35328
    s_waitcnt lgkmcnt(9)
    v_mfma_f32_32x32x16_bf16 v[48:63], v[92:95], a[52:55], v[48:63]
    s_add_u32 m0, s56, 5120
    s_add_u32 s62, s57, 143360
    buffer_load_dwordx4 v121, s[44:47], s62 offen lds
    ds_read_b64_tr_b16 v[92:93], v4 offset:36864
    ds_read_b64_tr_b16 v[94:95], v4 offset:37376
    s_waitcnt lgkmcnt(8)
    v_mfma_f32_32x32x16_bf16 v[48:63], v[96:99], a[56:59], v[48:63]
    s_add_u32 m0, s56, 6144
    s_add_u32 s62, s57, 172032
    buffer_load_dwordx4 v121, s[44:47], s62 offen lds
    ds_read_b64_tr_b16 v[96:97], v4 offset:38912
    ds_read_b64_tr_b16 v[98:99], v4 offset:39424
    s_waitcnt lgkmcnt(8)
    v_mfma_f32_32x32x16_bf16 v[48:63], v[80:83], a[60:63], v[48:63]
    s_add_u32 m0, s56, 7168
    s_add_u32 s62, s57, 200704
    buffer_load_dwordx4 v121, s[44:47], s62 offen lds
    ds_read_b64_tr_b16 v[80:81], v4 offset:40960
    ds_read_b64_tr_b16 v[82:83], v4 offset:41472
    s_waitcnt lgkmcnt(8)
    v_mfma_f32_32x32x16_bf16 v[48:63], v[84:87], a[64:67], v[48:63]
    s_add_u32 m0, s56, 8192
    s_add_u32 s62, s57, 229376
    buffer_load_dwordx4 v121, s[44:47], s62 offen lds
    ds_read_b64_tr_b16 v[84:85], v4 offset:43008
    ds_read_b64_tr_b16 v[86:87], v4 offset:43520
    s_waitcnt lgkmcnt(8)
    v_mfma_f32_32x32x16_bf16 v[48:63], v[88:91], a[68:71], v[48:63]
    s_add_u32 m0, s56, 9216
    s_add_u32 s62, s57, 258048
    buffer_load_dwordx4 v121, s[44:47], s62 offen lds
    ds_read_b64_tr_b16 v[88:89], v4 offset:45056
    ds_read_b64_tr_b16 v[90:91], v4 offset:45568
    s_waitcnt lgkmcnt(8)
    v_mfma_f32_32x32x16_bf16 v[48:63], v[92:95], a[72:75], v[48:63]
    s_add_u32 m0, s56, 10240
    s_add_u32 s62, s57, 286720
    buffer_load_dwordx4 v121, s[44:47], s62 offen lds
    ds_read_b64_tr_b16 v[92:93], v4 offset:47104
    ds_read_b64_tr_b16 v[94:95], v4 offset:47616
    s_waitcnt lgkmcnt(8)
    v_mfma_f32_32x32x16_bf16 v[48:63], v[96:99], a[76:79], v[48:63]
    s_add_u32 m0, s56, 11264
    s_add_u32 s62, s57, 315392
    buffer_load_dwordx4 v121, s[44:47], s62 offen lds
    ds_read_b64_tr_b16 v[96:97], v4 offset:49152
    ds_read_b64_tr_b16 v[98:99], v4 offset:49664
    s_waitcnt lgkmcnt(8)
    v_mfma_f32_32x32x16_bf16 v[48:63], v[80:83], a[80:83], v[48:63]
    s_add_u32 m0, s56, 12288
    s_add_u32 s62, s57, 344064
    buffer_load_dwordx4 v121, s[44:47], s62 offen lds
    ds_read_b64_tr_b16 v[80:81], v4 offset:51200
    ds_read_b64_tr_b16 v[82:83], v4 offset:51712
    s_waitcnt lgkmcnt(8)
    v_mfma_f32_32x32x16_bf16 v[48:63], v[84:87], a[84:87], v[48:63]
    s_add_u32 m0, s56, 13312
    s_add_u32 s62, s57, 372736
    buffer_load_dwordx4 v121, s[44:47], s62 offen lds
    ds_read_b64_tr_b16 v[84:85], v4 offset:53248
    ds_read_b64_tr_b16 v[86:87], v4 offset:53760
    s_waitcnt lgkmcnt(8)
    v_mfma_f32_32x32x16_bf16 v[48:63], v[88:91], a[88:91], v[48:63]
    s_add_u32 m0, s56, 14336
    s_add_u32 s62, s57, 401408
    buffer_load_dwordx4 v121, s[44:47], s62 offen lds
    ds_read_b64_tr_b16 v[88:89], v4 offset:55296
    ds_read_b64_tr_b16 v[90:91], v4 offset:55808
    s_waitcnt lgkmcnt(8)
    v_mfma_f32_32x32x16_bf16 v[48:63], v[92:95], a[92:95], v[48:63]
    s_add_u32 m0, s56, 15360
    s_add_u32 s62, s57, 430080
    buffer_load_dwordx4 v121, s[44:47], s62 offen lds
    s_waitcnt vmcnt(0) lgkmcnt(0)
    s_barrier
    ds_read_b64_tr_b16 v[92:93], v4 offset:57344
    ds_read_b64_tr_b16 v[94:95], v4 offset:57856
    v_mfma_f32_32x32x16_bf16 v[48:63], v[96:99], a[96:99], v[48:63]
    ds_read_b64 v[100:101], v10 offset:0
    ds_read_b64_tr_b16 v[96:97], v4 offset:59392
    ds_read_b64_tr_b16 v[98:99], v4 offset:59904
    v_mfma_f32_32x32x16_bf16 v[48:63], v[80:83], a[100:103], v[48:63]
    ds_read_b64_tr_b16 v[80:81], v4 offset:61440
    ds_read_b64_tr_b16 v[82:83], v4 offset:61952
    v_mfma_f32_32x32x16_bf16 v[48:63], v[84:87], a[104:107], v[48:63]
    ds_read_b64_tr_b16 v[84:85], v4 offset:63488
    ds_read_b64_tr_b16 v[86:87], v4 offset:64000
    v_mfma_f32_32x32x16_bf16 v[48:63], v[88:91], a[108:111], v[48:63]
    s_waitcnt lgkmcnt(7)
    v_mfma_f32_32x32x16_bf16 v[48:63], v[92:95], a[112:115], v[48:63]
    s_waitcnt lgkmcnt(4)
    v_mfma_f32_32x32x16_bf16 v[48:63], v[96:99], a[116:119], v[48:63]
    s_waitcnt lgkmcnt(2)
    v_mfma_f32_32x32x16_bf16 v[48:63], v[80:83], a[120:123], v[48:63]
    s_waitcnt lgkmcnt(0)
    v_mfma_f32_32x32x16_bf16 v[48:63], v[84:87], a[124:127], v[48:63]
    v_mfma_f32_32x32x16_bf16 v[48:63], v[100:103], v[104:107], v[48:63]
    ds_read_b64_tr_b16 v[80:81], v6 offset:0
    ds_read_b64_tr_b16 v[82:83], v6 offset:512
    ds_read_b64_tr_b16 v[84:85], v6 offset:2048
    ds_read_b64_tr_b16 v[86:87], v6 offset:2560
    ds_read_b64_tr_b16 v[88:89], v6 offset:4096
    ds_read_b64_tr_b16 v[90:91], v6 offset:4608
    ds_read_b64_tr_b16 v[92:93], v6 offset:6144
    ds_read_b64_tr_b16 v[94:95], v6 offset:6656
    ds_read_b64_tr_b16 v[96:97], v6 offset:8192
    ds_read_b64_tr_b16 v[98:99], v6 offset:8704
    s_waitcnt lgkmcnt(8)
    v_mfma_f32_32x32x16_bf16 v[64:79], v[80:83], a[0:3], 0
    v_mul_f32 v16, v48, v48
    v_mul_f32 v17, v49, v49
    v_mul_f32 v18, v50, v50
    v_mul_f32 v19, v51, v51
    v_fma_f32 v16, v16, v109, v108
    ds_read_b64_tr_b16 v[80:81], v6 offset:10240
    ds_read_b64_tr_b16 v[82:83], v6 offset:10752
    s_waitcnt lgkmcnt(8)
    v_mfma_f32_32x32x16_bf16 v[64:79], v[84:87], a[4:7], v[64:79]
    v_fma_f32 v17, v17, v109, v108
    v_fma_f32 v18, v18, v109, v108
    v_fma_f32 v19, v19, v109, v108
    v_mul_f32 v16, v16, v48
    v_mul_f32 v17, v17, v49
    ds_read_b64_tr_b16 v[84:85], v6 offset:12288
    ds_read_b64_tr_b16 v[86:87], v6 offset:12800
    s_waitcnt lgkmcnt(8)
    v_mfma_f32_32x32x16_bf16 v[64:79], v[88:91], a[8:11], v[64:79]
    v_mul_f32 v18, v18, v50
    v_mul_f32 v19, v19, v51
    v_exp_f32 v16, v16
    v_exp_f32 v17, v17
    v_exp_f32 v18, v18
    ds_read_b64_tr_b16 v[88:89], v6 offset:14336
    ds_read_b64_tr_b16 v[90:91], v6 offset:14848
    s_waitcnt lgkmcnt(8)
    v_mfma_f32_32x32x16_bf16 v[64:79], v[92:95], a[12:15], v[64:79]
    v_exp_f32 v19, v19
    v_fma_f32 v16, v16, v110, v110
    v_fma_f32 v17, v17, v110, v110
    v_fma_f32 v18, v18, v110, v110
    v_fma_f32 v19, v19, v110, v110
    ds_read_b64_tr_b16 v[92:93], v6 offset:16384
    ds_read_b64_tr_b16 v[94:95], v6 offset:16896
    s_waitcnt lgkmcnt(8)
    v_mfma_f32_32x32x16_bf16 v[64:79], v[96:99], a[16:19], v[64:79]
    v_rcp_f32 v16, v16
    v_rcp_f32 v17, v17
    v_rcp_f32 v18, v18
    v_rcp_f32 v19, v19
    v_mul_f32 v16, v16, v48
    ds_read_b64_tr_b16 v[96:97], v6 offset:18432
    ds_read_b64_tr_b16 v[98:99], v6 offset:18944
    s_waitcnt lgkmcnt(8)
    v_mfma_f32_32x32x16_bf16 v[64:79], v[80:83], a[20:23], v[64:79]
    v_mul_f32 v17, v17, v49
    v_mul_f32 v18, v18, v50
    v_mul_f32 v19, v19, v51
    v_cvt_pk_bf16_f32 v16, v16, v17
    v_cvt_pk_bf16_f32 v17, v18, v19
    ds_read_b64_tr_b16 v[80:81], v6 offset:20480
    ds_read_b64_tr_b16 v[82:83], v6 offset:20992
    s_waitcnt lgkmcnt(8)
    v_mfma_f32_32x32x16_bf16 v[64:79], v[84:87], a[24:27], v[64:79]
    v_mul_f32 v20, v52, v52
    v_mul_f32 v21, v53, v53
    v_mul_f32 v22, v54, v54
    v_mul_f32 v23, v55, v55
    v_fma_f32 v20, v20, v109, v108
    ds_read_b64_tr_b16 v[84:85], v6 offset:22528
    ds_read_b64_tr_b16 v[86:87], v6 offset:23040
    s_waitcnt lgkmcnt(8)
    v_mfma_f32_32x32x16_bf16 v[64:79], v[88:91], a[28:31], v[64:79]
    v_fma_f32 v21, v21, v109, v108
    v_fma_f32 v22, v22, v109, v108
    v_fma_f32 v23, v23, v109, v108
    v_mul_f32 v20, v20, v52
    v_mul_f32 v21, v21, v53
    ds_read_b64_tr_b16 v[88:89], v6 offset:24576
    ds_read_b64_tr_b16 v[90:91], v6 offset:25088
    s_waitcnt lgkmcnt(8)
    v_mfma_f32_32x32x16_bf16 v[64:79], v[92:95], a[32:35], v[64:79]
    v_mul_f32 v22, v22, v54
    v_mul_f32 v23, v23, v55
    v_exp_f32 v20, v20
    v_exp_f32 v21, v21
    v_exp_f32 v22, v22
    ds_read_b64_tr_b16 v[92:93], v6 offset:26624
    ds_read_b64_tr_b16 v[94:95], v6 offset:27136
    s_waitcnt lgkmcnt(8)
    v_mfma_f32_32x32x16_bf16 v[64:79], v[96:99], a[36:39], v[64:79]
    v_exp_f32 v23, v23
    v_fma_f32 v20, v20, v110, v110
    v_fma_f32 v21, v21, v110, v110
    v_fma_f32 v22, v22, v110, v110
    v_fma_f32 v23, v23, v110, v110
    ds_read_b64_tr_b16 v[96:97], v6 offset:28672
    ds_read_b64_tr_b16 v[98:99], v6 offset:29184
    s_waitcnt lgkmcnt(8)
    v_mfma_f32_32x32x16_bf16 v[64:79], v[80:83], a[40:43], v[64:79]
    v_rcp_f32 v20, v20
    v_rcp_f32 v21, v21
    v_rcp_f32 v22, v22
    v_rcp_f32 v23, v23
    v_mul_f32 v20, v20, v52
    ds_read_b64_tr_b16 v[80:81], v6 offset:30720
    ds_read_b64_tr_b16 v[82:83], v6 offset:31232
    s_waitcnt lgkmcnt(8)
    v_mfma_f32_32x32x16_bf16 v[64:79], v[84:87], a[44:47], v[64:79]
    v_mul_f32 v21, v21, v53
    v_mul_f32 v22, v22, v54
    v_mul_f32 v23, v23, v55
    v_cvt_pk_bf16_f32 v20, v20, v21
    v_cvt_pk_bf16_f32 v21, v22, v23
    ds_read_b64_tr_b16 v[84:85], v6 offset:32768
    ds_read_b64_tr_b16 v[86:87], v6 offset:33280
    s_waitcnt lgkmcnt(8)
    v_mfma_f32_32x32x16_bf16 v[64:79], v[88:91], a[48:51], v[64:79]
    v_mov_b32 v18, v20
    v_mov_b32 v19, v21
    s_add_u32 s61, s63, 0
    buffer_store_dwordx4 v[16:19], v9, s[32:35], s61 offen sc0 sc1
    v_mul_f32 v24, v56, v56
    ds_read_b64_tr_b16 v[88:89], v6 offset:34816
    ds_read_b64_tr_b16 v[90:91], v6 offset:35328
    s_waitcnt lgkmcnt(8)
    v_mfma_f32_32x32x16_bf16 v[64:79], v[92:95], a[52:55], v[64:79]
    v_mul_f32 v25, v57, v57
    v_mul_f32 v26, v58, v58
    v_mul_f32 v27, v59, v59
    v_fma_f32 v24, v24, v109, v108
    v_fma_f32 v25, v25, v109, v108
    ds_read_b64_tr_b16 v[92:93], v6 offset:36864
    ds_read_b64_tr_b16 v[94:95], v6 offset:37376
    s_waitcnt lgkmcnt(8)
    v_mfma_f32_32x32x16_bf16 v[64:79], v[96:99], a[56:59], v[64:79]
    v_fma_f32 v26, v26, v109, v108
    v_fma_f32 v27, v27, v109, v108
    v_mul_f32 v24, v24, v56
    v_mul_f32 v25, v25, v57
    v_mul_f32 v26, v26, v58
    ds_read_b64_tr_b16 v[96:97], v6 offset:38912
    ds_read_b64_tr_b16 v[98:99], v6 offset:39424
    s_waitcnt lgkmcnt(8)
    v_mfma_f32_32x32x16_bf16 v[64:79], v[80:83], a[60:63], v[64:79]
    v_mul_f32 v27, v27, v59
    v_exp_f32 v24, v24
    v_exp_f32 v25, v25
    v_exp_f32 v26, v26
    v_exp_f32 v27, v27
    ds_read_b64_tr_b16 v[80:81], v6 offset:40960
    ds_read_b64_tr_b16 v[82:83], v6 offset:41472
    s_waitcnt lgkmcnt(8)
    v_mfma_f32_32x32x16_bf16 v[64:79], v[84:87], a[64:67], v[64:79]
    v_fma_f32 v24, v24, v110, v110
    v_fma_f32 v25, v25, v110, v110
    v_fma_f32 v26, v26, v110, v110
    v_fma_f32 v27, v27, v110, v110
    v_rcp_f32 v24, v24
    ds_read_b64_tr_b16 v[84:85], v6 offset:43008
    ds_read_b64_tr_b16 v[86:87], v6 offset:43520
    s_waitcnt lgkmcnt(8)
    v_mfma_f32_32x32x16_bf16 v[64:79], v[88:91], a[68:71], v[64:79]
    v_rcp_f32 v25, v25
    v_rcp_f32 v26, v26
    v_rcp_f32 v27, v27
    v_mul_f32 v24, v24, v56
    v_mul_f32 v25, v25, v57
    ds_read_b64_tr_b16 v[88:89], v6 offset:45056
    ds_read_b64_tr_b16 v[90:91], v6 offset:45568
    s_waitcnt lgkmcnt(8)
    v_mfma_f32_32x32x16_bf16 v[64:79], v[92:95], a[72:75], v[64:79]
    v_mul_f32 v26, v26, v58
    v_mul_f32 v27, v27, v59
    v_cvt_pk_bf16_f32 v24, v24, v25
    v_cvt_pk_bf16_f32 v25, v26, v27
    v_mul_f32 v28, v60, v60
    ds_read_b64_tr_b16 v[92:93], v6 offset:47104
    ds_read_b64_tr_b16 v[94:95], v6 offset:47616
    s_waitcnt lgkmcnt(8)
    v_mfma_f32_32x32x16_bf16 v[64:79], v[96:99], a[76:79], v[64:79]
    v_mul_f32 v29, v61, v61
    v_mul_f32 v30, v62, v62
    v_mul_f32 v31, v63, v63
    v_fma_f32 v28, v28, v109, v108
    v_fma_f32 v29, v29, v109, v108
    ds_read_b64_tr_b16 v[96:97], v8 offset:0
    ds_read_b64_tr_b16 v[98:99], v8 offset:512
    s_waitcnt lgkmcnt(8)
    v_mfma_f32_32x32x16_bf16 v[64:79], v[80:83], a[80:83], v[64:79]
    v_fma_f32 v30, v30, v109, v108
    v_fma_f32 v31, v31, v109, v108
    v_mul_f32 v28, v28, v60
    v_mul_f32 v29, v29, v61
    v_mul_f32 v30, v30, v62
    ds_read_b64_tr_b16 v[80:81], v8 offset:2048
    ds_read_b64_tr_b16 v[82:83], v8 offset:2560
    s_waitcnt lgkmcnt(8)
    v_mfma_f32_32x32x16_bf16 v[64:79], v[84:87], a[84:87], v[64:79]
    v_mul_f32 v31, v31, v63
    v_exp_f32 v28, v28
    v_exp_f32 v29, v29
    v_exp_f32 v30, v30
    v_exp_f32 v31, v31
    ds_read_b64_tr_b16 v[84:85], v8 offset:4096
    ds_read_b64_tr_b16 v[86:87], v8 offset:4608
    s_waitcnt lgkmcnt(8)
    v_mfma_f32_32x32x16_bf16 v[64:79], v[88:91], a[88:91], v[64:79]
    v_fma_f32 v28, v28, v110, v110
    v_fma_f32 v29, v29, v110, v110
    v_fma_f32 v30, v30, v110, v110
    v_fma_f32 v31, v31, v110, v110
    v_rcp_f32 v28, v28
    ds_read_b64_tr_b16 v[88:89], v8 offset:6144
    ds_read_b64_tr_b16 v[90:91], v8 offset:6656
    s_waitcnt lgkmcnt(8)
    v_mfma_f32_32x32x16_bf16 v[64:79], v[92:95], a[92:95], v[64:79]
    v_rcp_f32 v29, v29
    v_rcp_f32 v30, v30
    v_rcp_f32 v31, v31
    v_mul_f32 v28, v28, v60
    v_mul_f32 v29, v29, v61
    ds_read_b64_tr_b16 v[92:93], v8 offset:8192
    ds_read_b64_tr_b16 v[94:95], v8 offset:8704
    s_waitcnt lgkmcnt(8)
    v_mfma_f32_32x32x16_bf16 v[64:79], v[96:99], a[96:99], v[64:79]
    v_mul_f32 v30, v30, v62
    v_mul_f32 v31, v31, v63
    v_cvt_pk_bf16_f32 v28, v28, v29
    v_cvt_pk_bf16_f32 v29, v30, v31
    v_mov_b32 v26, v28
    ds_read_b64_tr_b16 v[96:97], v8 offset:10240
    ds_read_b64_tr_b16 v[98:99], v8 offset:10752
    s_waitcnt lgkmcnt(8)
    v_mfma_f32_32x32x16_bf16 v[64:79], v[80:83], a[100:103], v[64:79]
    v_mov_b32 v27, v29
    s_add_u32 s61, s63, 2048
    buffer_store_dwordx4 v[24:27], v9, s[32:35], s61 offen sc0 sc1
    ds_read_b64 v[100:101], v10 offset:512
    ds_read_b64_tr_b16 v[80:81], v8 offset:12288
    ds_read_b64_tr_b16 v[82:83], v8 offset:12800
    s_waitcnt lgkmcnt(9)
    v_mfma_f32_32x32x16_bf16 v[64:79], v[84:87], a[104:107], v[64:79]
    ds_read_b64_tr_b16 v[84:85], v8 offset:14336
    ds_read_b64_tr_b16 v[86:87], v8 offset:14848
    s_waitcnt lgkmcnt(9)
    v_mfma_f32_32x32x16_bf16 v[64:79], v[88:91], a[108:111], v[64:79]
    s_waitcnt lgkmcnt(7)
    v_mfma_f32_32x32x16_bf16 v[64:79], v[92:95], a[112:115], v[64:79]
    s_waitcnt lgkmcnt(5)
    v_mfma_f32_32x32x16_bf16 v[64:79], v[96:99], a[116:119], v[64:79]
    s_waitcnt lgkmcnt(2)
    v_mfma_f32_32x32x16_bf16 v[64:79], v[80:83], a[120:123], v[64:79]
    s_waitcnt lgkmcnt(0)
    v_mfma_f32_32x32x16_bf16 v[64:79], v[84:87], a[124:127], v[64:79]
    v_mfma_f32_32x32x16_bf16 v[64:79], v[100:103], v[104:107], v[64:79]
    ds_read_b64_tr_b16 v[80:81], v7 offset:0
    ds_read_b64_tr_b16 v[82:83], v7 offset:512
    ds_read_b64_tr_b16 v[84:85], v7 offset:2048
    ds_read_b64_tr_b16 v[86:87], v7 offset:2560
    ds_read_b64_tr_b16 v[88:89], v7 offset:4096
    ds_read_b64_tr_b16 v[90:91], v7 offset:4608
    ds_read_b64_tr_b16 v[92:93], v7 offset:6144
    ds_read_b64_tr_b16 v[94:95], v7 offset:6656
    ds_read_b64_tr_b16 v[96:97], v7 offset:8192
    ds_read_b64_tr_b16 v[98:99], v7 offset:8704
    s_waitcnt lgkmcnt(8)
    v_mfma_f32_32x32x16_bf16 v[48:63], v[80:83], a[0:3], 0
    v_mul_f32 v16, v64, v64
    v_mul_f32 v17, v65, v65
    v_mul_f32 v18, v66, v66
    v_mul_f32 v19, v67, v67
    v_fma_f32 v16, v16, v109, v108
    ds_read_b64_tr_b16 v[80:81], v7 offset:10240
    ds_read_b64_tr_b16 v[82:83], v7 offset:10752
    s_waitcnt lgkmcnt(8)
    v_mfma_f32_32x32x16_bf16 v[48:63], v[84:87], a[4:7], v[48:63]
    v_fma_f32 v17, v17, v109, v108
    v_fma_f32 v18, v18, v109, v108
    v_fma_f32 v19, v19, v109, v108
    v_mul_f32 v16, v16, v64
    v_mul_f32 v17, v17, v65
    ds_read_b64_tr_b16 v[84:85], v7 offset:12288
    ds_read_b64_tr_b16 v[86:87], v7 offset:12800
    s_waitcnt lgkmcnt(8)
    v_mfma_f32_32x32x16_bf16 v[48:63], v[88:91], a[8:11], v[48:63]
    v_mul_f32 v18, v18, v66
    v_mul_f32 v19, v19, v67
    v_exp_f32 v16, v16
    v_exp_f32 v17, v17
    v_exp_f32 v18, v18
    ds_read_b64_tr_b16 v[88:89], v7 offset:14336
    ds_read_b64_tr_b16 v[90:91], v7 offset:14848
    s_waitcnt lgkmcnt(8)
    v_mfma_f32_32x32x16_bf16 v[48:63], v[92:95], a[12:15], v[48:63]
    v_exp_f32 v19, v19
    v_fma_f32 v16, v16, v110, v110
    v_fma_f32 v17, v17, v110, v110
    v_fma_f32 v18, v18, v110, v110
    v_fma_f32 v19, v19, v110, v110
    ds_read_b64_tr_b16 v[92:93], v7 offset:16384
    ds_read_b64_tr_b16 v[94:95], v7 offset:16896
    s_waitcnt lgkmcnt(8)
    v_mfma_f32_32x32x16_bf16 v[48:63], v[96:99], a[16:19], v[48:63]
    v_rcp_f32 v16, v16
    v_rcp_f32 v17, v17
    v_rcp_f32 v18, v18
    v_rcp_f32 v19, v19
    v_mul_f32 v16, v16, v64
    ds_read_b64_tr_b16 v[96:97], v7 offset:18432
    ds_read_b64_tr_b16 v[98:99], v7 offset:18944
    s_waitcnt lgkmcnt(8)
    v_mfma_f32_32x32x16_bf16 v[48:63], v[80:83], a[20:23], v[48:63]
    v_mul_f32 v17, v17, v65
    v_mul_f32 v18, v18, v66
    v_mul_f32 v19, v19, v67
    v_cvt_pk_bf16_f32 v16, v16, v17
    v_cvt_pk_bf16_f32 v17, v18, v19
    ds_read_b64_tr_b16 v[80:81], v7 offset:20480
    ds_read_b64_tr_b16 v[82:83], v7 offset:20992
    s_waitcnt lgkmcnt(8)
    v_mfma_f32_32x32x16_bf16 v[48:63], v[84:87], a[24:27], v[48:63]
    v_mul_f32 v20, v68, v68
    v_mul_f32 v21, v69, v69
    v_mul_f32 v22, v70, v70
    v_mul_f32 v23, v71, v71
    v_fma_f32 v20, v20, v109, v108
    ds_read_b64_tr_b16 v[84:85], v7 offset:22528
    ds_read_b64_tr_b16 v[86:87], v7 offset:23040
    s_waitcnt lgkmcnt(8)
    v_mfma_f32_32x32x16_bf16 v[48:63], v[88:91], a[28:31], v[48:63]
    v_fma_f32 v21, v21, v109, v108
    v_fma_f32 v22, v22, v109, v108
    v_fma_f32 v23, v23, v109, v108
    v_mul_f32 v20, v20, v68
    v_mul_f32 v21, v21, v69
    ds_read_b64_tr_b16 v[88:89], v7 offset:24576
    ds_read_b64_tr_b16 v[90:91], v7 offset:25088
    s_waitcnt lgkmcnt(8)
    v_mfma_f32_32x32x16_bf16 v[48:63], v[92:95], a[32:35], v[48:63]
    v_mul_f32 v22, v22, v70
    v_mul_f32 v23, v23, v71
    v_exp_f32 v20, v20
    v_exp_f32 v21, v21
    v_exp_f32 v22, v22
    ds_read_b64_tr_b16 v[92:93], v7 offset:26624
    ds_read_b64_tr_b16 v[94:95], v7 offset:27136
    s_waitcnt lgkmcnt(8)
    v_mfma_f32_32x32x16_bf16 v[48:63], v[96:99], a[36:39], v[48:63]
    v_exp_f32 v23, v23
    v_fma_f32 v20, v20, v110, v110
    v_fma_f32 v21, v21, v110, v110
    v_fma_f32 v22, v22, v110, v110
    v_fma_f32 v23, v23, v110, v110
    ds_read_b64_tr_b16 v[96:97], v7 offset:28672
    ds_read_b64_tr_b16 v[98:99], v7 offset:29184
    s_waitcnt lgkmcnt(8)
    v_mfma_f32_32x32x16_bf16 v[48:63], v[80:83], a[40:43], v[48:63]
    v_rcp_f32 v20, v20
    v_rcp_f32 v21, v21
    v_rcp_f32 v22, v22
    v_rcp_f32 v23, v23
    v_mul_f32 v20, v20, v68
    ds_read_b64_tr_b16 v[80:81], v7 offset:30720
    ds_read_b64_tr_b16 v[82:83], v7 offset:31232
    s_waitcnt lgkmcnt(8)
    v_mfma_f32_32x32x16_bf16 v[48:63], v[84:87], a[44:47], v[48:63]
    v_mul_f32 v21, v21, v69
    v_mul_f32 v22, v22, v70
    v_mul_f32 v23, v23, v71
    v_cvt_pk_bf16_f32 v20, v20, v21
    v_cvt_pk_bf16_f32 v21, v22, v23
    ds_read_b64_tr_b16 v[84:85], v7 offset:32768
    ds_read_b64_tr_b16 v[86:87], v7 offset:33280
    s_waitcnt lgkmcnt(8)
    v_mfma_f32_32x32x16_bf16 v[48:63], v[88:91], a[48:51], v[48:63]
    v_mov_b32 v18, v20
    v_mov_b32 v19, v21
    s_add_u32 s61, s63, 8192
    buffer_store_dwordx4 v[16:19], v9, s[32:35], s61 offen sc0 sc1
    v_mul_f32 v24, v72, v72
    ds_read_b64_tr_b16 v[88:89], v7 offset:34816
    ds_read_b64_tr_b16 v[90:91], v7 offset:35328
    s_waitcnt lgkmcnt(8)
    v_mfma_f32_32x32x16_bf16 v[48:63], v[92:95], a[52:55], v[48:63]
    v_mul_f32 v25, v73, v73
    v_mul_f32 v26, v74, v74
    v_mul_f32 v27, v75, v75
    v_fma_f32 v24, v24, v109, v108
    v_fma_f32 v25, v25, v109, v108
    ds_read_b64_tr_b16 v[92:93], v7 offset:36864
    ds_read_b64_tr_b16 v[94:95], v7 offset:37376
    s_waitcnt lgkmcnt(8)
    v_mfma_f32_32x32x16_bf16 v[48:63], v[96:99], a[56:59], v[48:63]
    v_fma_f32 v26, v26, v109, v108
    v_fma_f32 v27, v27, v109, v108
    v_mul_f32 v24, v24, v72
    v_mul_f32 v25, v25, v73
    v_mul_f32 v26, v26, v74
    ds_read_b64_tr_b16 v[96:97], v7 offset:38912
    ds_read_b64_tr_b16 v[98:99], v7 offset:39424
    s_waitcnt lgkmcnt(8)
    v_mfma_f32_32x32x16_bf16 v[48:63], v[80:83], a[60:63], v[48:63]
    v_mul_f32 v27, v27, v75
    v_exp_f32 v24, v24
    v_exp_f32 v25, v25
    v_exp_f32 v26, v26
    v_exp_f32 v27, v27
    ds_read_b64_tr_b16 v[80:81], v7 offset:40960
    ds_read_b64_tr_b16 v[82:83], v7 offset:41472
    s_waitcnt lgkmcnt(8)
    v_mfma_f32_32x32x16_bf16 v[48:63], v[84:87], a[64:67], v[48:63]
    v_fma_f32 v24, v24, v110, v110
    v_fma_f32 v25, v25, v110, v110
    v_fma_f32 v26, v26, v110, v110
    v_fma_f32 v27, v27, v110, v110
    v_rcp_f32 v24, v24
    ds_read_b64_tr_b16 v[84:85], v7 offset:43008
    ds_read_b64_tr_b16 v[86:87], v7 offset:43520
    s_waitcnt lgkmcnt(8)
    v_mfma_f32_32x32x16_bf16 v[48:63], v[88:91], a[68:71], v[48:63]
    v_rcp_f32 v25, v25
    v_rcp_f32 v26, v26
    v_rcp_f32 v27, v27
    v_mul_f32 v24, v24, v72
    v_mul_f32 v25, v25, v73
    ds_read_b64_tr_b16 v[88:89], v7 offset:45056
    ds_read_b64_tr_b16 v[90:91], v7 offset:45568
    s_waitcnt lgkmcnt(8)
    v_mfma_f32_32x32x16_bf16 v[48:63], v[92:95], a[72:75], v[48:63]
    v_mul_f32 v26, v26, v74
    v_mul_f32 v27, v27, v75
    v_cvt_pk_bf16_f32 v24, v24, v25
    v_cvt_pk_bf16_f32 v25, v26, v27
    v_mul_f32 v28, v76, v76
    ds_read_b64_tr_b16 v[92:93], v7 offset:47104
    ds_read_b64_tr_b16 v[94:95], v7 offset:47616
    s_waitcnt lgkmcnt(8)
    v_mfma_f32_32x32x16_bf16 v[48:63], v[96:99], a[76:79], v[48:63]
    v_mul_f32 v29, v77, v77
    v_mul_f32 v30, v78, v78
    v_mul_f32 v31, v79, v79
    v_fma_f32 v28, v28, v109, v108
    v_fma_f32 v29, v29, v109, v108
    ds_read_b64_tr_b16 v[96:97], v11 offset:0
    ds_read_b64_tr_b16 v[98:99], v11 offset:512
    s_waitcnt lgkmcnt(8)
    v_mfma_f32_32x32x16_bf16 v[48:63], v[80:83], a[80:83], v[48:63]
    v_fma_f32 v30, v30, v109, v108
    v_fma_f32 v31, v31, v109, v108
    v_mul_f32 v28, v28, v76
    v_mul_f32 v29, v29, v77
    v_mul_f32 v30, v30, v78
    ds_read_b64_tr_b16 v[80:81], v11 offset:2048
    ds_read_b64_tr_b16 v[82:83], v11 offset:2560
    s_waitcnt lgkmcnt(8)
    v_mfma_f32_32x32x16_bf16 v[48:63], v[84:87], a[84:87], v[48:63]
    v_mul_f32 v31, v31, v79
    v_exp_f32 v28, v28
    v_exp_f32 v29, v29
    v_exp_f32 v30, v30
    v_exp_f32 v31, v31
    ds_read_b64_tr_b16 v[84:85], v11 offset:4096
    ds_read_b64_tr_b16 v[86:87], v11 offset:4608
    s_waitcnt lgkmcnt(8)
    v_mfma_f32_32x32x16_bf16 v[48:63], v[88:91], a[88:91], v[48:63]
    v_fma_f32 v28, v28, v110, v110
    v_fma_f32 v29, v29, v110, v110
    v_fma_f32 v30, v30, v110, v110
    v_fma_f32 v31, v31, v110, v110
    v_rcp_f32 v28, v28
    ds_read_b64_tr_b16 v[88:89], v11 offset:6144
    ds_read_b64_tr_b16 v[90:91], v11 offset:6656
    s_waitcnt lgkmcnt(8)
    v_mfma_f32_32x32x16_bf16 v[48:63], v[92:95], a[92:95], v[48:63]
    v_rcp_f32 v29, v29
    v_rcp_f32 v30, v30
    v_rcp_f32 v31, v31
    v_mul_f32 v28, v28, v76
    v_mul_f32 v29, v29, v77
    ds_read_b64_tr_b16 v[92:93], v11 offset:8192
    ds_read_b64_tr_b16 v[94:95], v11 offset:8704
    s_waitcnt lgkmcnt(8)
    v_mfma_f32_32x32x16_bf16 v[48:63], v[96:99], a[96:99], v[48:63]
    v_mul_f32 v30, v30, v78
    v_mul_f32 v31, v31, v79
    v_cvt_pk_bf16_f32 v28, v28, v29
    v_cvt_pk_bf16_f32 v29, v30, v31
    v_mov_b32 v26, v28
    ds_read_b64_tr_b16 v[96:97], v11 offset:10240
    ds_read_b64_tr_b16 v[98:99], v11 offset:10752
    s_waitcnt lgkmcnt(8)
    v_mfma_f32_32x32x16_bf16 v[48:63], v[80:83], a[100:103], v[48:63]
    v_mov_b32 v27, v29
    s_add_u32 s61, s63, 10240
    buffer_store_dwordx4 v[24:27], v9, s[32:35], s61 offen sc0 sc1
    ds_read_b64 v[100:101], v10 offset:768
    ds_read_b64_tr_b16 v[80:81], v11 offset:12288
    ds_read_b64_tr_b16 v[82:83], v11 offset:12800
    s_waitcnt lgkmcnt(9)
    v_mfma_f32_32x32x16_bf16 v[48:63], v[84:87], a[104:107], v[48:63]
    ds_read_b64_tr_b16 v[84:85], v11 offset:14336
    ds_read_b64_tr_b16 v[86:87], v11 offset:14848
    s_waitcnt lgkmcnt(9)
    v_mfma_f32_32x32x16_bf16 v[48:63], v[88:91], a[108:111], v[48:63]
    s_waitcnt lgkmcnt(7)
    v_mfma_f32_32x32x16_bf16 v[48:63], v[92:95], a[112:115], v[48:63]
    s_waitcnt lgkmcnt(5)
    v_mfma_f32_32x32x16_bf16 v[48:63], v[96:99], a[116:119], v[48:63]
    s_waitcnt lgkmcnt(2)
    v_mfma_f32_32x32x16_bf16 v[48:63], v[80:83], a[120:123], v[48:63]
    s_waitcnt lgkmcnt(0)
    v_mfma_f32_32x32x16_bf16 v[48:63], v[84:87], a[124:127], v[48:63]
    v_mfma_f32_32x32x16_bf16 v[48:63], v[100:103], v[104:107], v[48:63]
    s_nop 11
    v_mul_f32 v16, v48, v48
    v_mul_f32 v17, v49, v49
    v_mul_f32 v18, v50, v50
    v_mul_f32 v19, v51, v51
    v_fma_f32 v16, v16, v109, v108
    v_fma_f32 v17, v17, v109, v108
    v_fma_f32 v18, v18, v109, v108
    v_fma_f32 v19, v19, v109, v108
    v_mul_f32 v16, v16, v48
    v_mul_f32 v17, v17, v49
    v_mul_f32 v18, v18, v50
    v_mul_f32 v19, v19, v51
    v_exp_f32 v16, v16
    v_exp_f32 v17, v17
    v_exp_f32 v18, v18
    v_exp_f32 v19, v19
    v_fma_f32 v16, v16, v110, v110
    v_fma_f32 v17, v17, v110, v110
    v_fma_f32 v18, v18, v110, v110
    v_fma_f32 v19, v19, v110, v110
    v_rcp_f32 v16, v16
    v_rcp_f32 v17, v17
    v_rcp_f32 v18, v18
    v_rcp_f32 v19, v19
    v_mul_f32 v16, v16, v48
    v_mul_f32 v17, v17, v49
    v_mul_f32 v18, v18, v50
    v_mul_f32 v19, v19, v51
    v_cvt_pk_bf16_f32 v16, v16, v17
    v_cvt_pk_bf16_f32 v17, v18, v19
    v_mul_f32 v20, v52, v52
    v_mul_f32 v21, v53, v53
    v_mul_f32 v22, v54, v54
    v_mul_f32 v23, v55, v55
    v_fma_f32 v20, v20, v109, v108
    v_fma_f32 v21, v21, v109, v108
    v_fma_f32 v22, v22, v109, v108
    v_fma_f32 v23, v23, v109, v108
    v_mul_f32 v20, v20, v52
    v_mul_f32 v21, v21, v53
    v_mul_f32 v22, v22, v54
    v_mul_f32 v23, v23, v55
    v_exp_f32 v20, v20
    v_exp_f32 v21, v21
    v_exp_f32 v22, v22
    v_exp_f32 v23, v23
    v_fma_f32 v20, v20, v110, v110
    v_fma_f32 v21, v21, v110, v110
    v_fma_f32 v22, v22, v110, v110
    v_fma_f32 v23, v23, v110, v110
    v_rcp_f32 v20, v20
    v_rcp_f32 v21, v21
    v_rcp_f32 v22, v22
    v_rcp_f32 v23, v23
    v_mul_f32 v20, v20, v52
    v_mul_f32 v21, v21, v53
    v_mul_f32 v22, v22, v54
    v_mul_f32 v23, v23, v55
    v_cvt_pk_bf16_f32 v20, v20, v21
    v_cvt_pk_bf16_f32 v21, v22, v23
    v_mov_b32 v18, v20
    v_mov_b32 v19, v21
    s_add_u32 s61, s63, 12288
    buffer_store_dwordx4 v[16:19], v9, s[32:35], s61 offen sc0 sc1
    v_mul_f32 v24, v56, v56
    v_mul_f32 v25, v57, v57
    v_mul_f32 v26, v58, v58
    v_mul_f32 v27, v59, v59
    v_fma_f32 v24, v24, v109, v108
    v_fma_f32 v25, v25, v109, v108
    v_fma_f32 v26, v26, v109, v108
    v_fma_f32 v27, v27, v109, v108
    v_mul_f32 v24, v24, v56
    v_mul_f32 v25, v25, v57
    v_mul_f32 v26, v26, v58
    v_mul_f32 v27, v27, v59
    v_exp_f32 v24, v24
    v_exp_f32 v25, v25
    v_exp_f32 v26, v26
    v_exp_f32 v27, v27
    v_fma_f32 v24, v24, v110, v110
    v_fma_f32 v25, v25, v110, v110
    v_fma_f32 v26, v26, v110, v110
    v_fma_f32 v27, v27, v110, v110
    v_rcp_f32 v24, v24
    v_rcp_f32 v25, v25
    v_rcp_f32 v26, v26
    v_rcp_f32 v27, v27
    v_mul_f32 v24, v24, v56
    v_mul_f32 v25, v25, v57
    v_mul_f32 v26, v26, v58
    v_mul_f32 v27, v27, v59
    v_cvt_pk_bf16_f32 v24, v24, v25
    v_cvt_pk_bf16_f32 v25, v26, v27
    v_mul_f32 v28, v60, v60
    v_mul_f32 v29, v61, v61
    v_mul_f32 v30, v62, v62
    v_mul_f32 v31, v63, v63
    v_fma_f32 v28, v28, v109, v108
    v_fma_f32 v29, v29, v109, v108
    v_fma_f32 v30, v30, v109, v108
    v_fma_f32 v31, v31, v109, v108
    v_mul_f32 v28, v28, v60
    v_mul_f32 v29, v29, v61
    v_mul_f32 v30, v30, v62
    v_mul_f32 v31, v31, v63
    v_exp_f32 v28, v28
    v_exp_f32 v29, v29
    v_exp_f32 v30, v30
    v_exp_f32 v31, v31
    v_fma_f32 v28, v28, v110, v110
    v_fma_f32 v29, v29, v110, v110
    v_fma_f32 v30, v30, v110, v110
    v_fma_f32 v31, v31, v110, v110
    v_rcp_f32 v28, v28
    v_rcp_f32 v29, v29
    v_rcp_f32 v30, v30
    v_rcp_f32 v31, v31
    v_mul_f32 v28, v28, v60
    v_mul_f32 v29, v29, v61
    v_mul_f32 v30, v30, v62
    v_mul_f32 v31, v31, v63
    v_cvt_pk_bf16_f32 v28, v28, v29
    v_cvt_pk_bf16_f32 v29, v30, v31
    v_mov_b32 v26, v28
    v_mov_b32 v27, v29
    s_add_u32 s61, s63, 14336
    buffer_store_dwordx4 v[24:27], v9, s[32:35], s61 offen sc0 sc1
    s_branch parallel_sum__ssm_conv_s5__dense_activation_gelu__prompt_kernel_P2
parallel_sum__ssm_conv_s5__dense_activation_gelu__prompt_kernel_lightB:
    s_lshl_b32 s70, s27, 2
    s_lshr_b32 s71, s28, 2
    s_add_u32 s70, s70, s71
    s_mov_b32 s72, s64
    s_and_b32 s73, s65, 0xffff
    s_mov_b32 s74, 524288
    s_mov_b32 s75, 0x00020000
    s_mov_b32 s84, s66
    s_and_b32 s85, s67, 0xffff
    s_mov_b32 s86, 524288
    s_mov_b32 s87, 0x00020000
    s_mov_b32 s44, s68
    s_and_b32 s45, s69, 0xffff
    s_mov_b32 s46, 1835008
    s_mov_b32 s47, 0x00020000
    v_lshrrev_b32 v13, 3, v1
    v_bfe_u32 v19, v1, 4, 1
    v_lshlrev_b32 v19, 2, v19
    v_and_b32 v15, 7, v1
    v_xor_b32 v19, v19, v15
    v_lshlrev_b32 v19, 4, v19
    v_lshl_add_u32 v12, v13, 10, v19
    s_lshl_b32 s71, s24, 13
    s_add_u32 s71, s71, 114688
    s_add_u32 s64, s24, 0
    s_min_u32 s64, s64, 13
    s_lshr_b32 s65, s70, 3
    s_mul_i32 s65, s65, 14
    s_add_u32 s65, s65, s64
    s_and_b32 s66, s70, 7
    s_lshl_b32 s67, s65, 14
    s_lshl_b32 s68, s66, 7
    s_add_u32 s67, s67, s68
    s_add_u32 m0, s71, 0
    s_add_u32 s62, s67, 0
    buffer_load_dwordx4 v12, s[44:47], s62 offen lds
    s_add_u32 m0, s71, 1024
    s_add_u32 s62, s67, 8192
    buffer_load_dwordx4 v12, s[44:47], s62 offen lds
    s_add_u32 s64, s24, 4
    s_min_u32 s64, s64, 13
    s_lshr_b32 s65, s70, 3
    s_mul_i32 s65, s65, 14
    s_add_u32 s65, s65, s64
    s_and_b32 s66, s70, 7
    s_lshl_b32 s67, s65, 14
    s_lshl_b32 s68, s66, 7
    s_add_u32 s67, s67, s68
    s_add_u32 m0, s71, 2048
    s_add_u32 s62, s67, 0
    buffer_load_dwordx4 v12, s[44:47], s62 offen lds
    s_add_u32 m0, s71, 3072
    s_add_u32 s62, s67, 8192
    buffer_load_dwordx4 v12, s[44:47], s62 offen lds
    s_barrier
    s_add_u32 s64, s24, 8
    s_min_u32 s64, s64, 13
    s_lshr_b32 s65, s70, 3
    s_mul_i32 s65, s65, 14
    s_add_u32 s65, s65, s64
    s_and_b32 s66, s70, 7
    s_lshl_b32 s67, s65, 14
    s_lshl_b32 s68, s66, 7
    s_add_u32 s67, s67, s68
    s_add_u32 m0, s71, 4096
    s_add_u32 s62, s67, 0
    buffer_load_dwordx4 v12, s[44:47], s62 offen lds
    s_add_u32 m0, s71, 5120
    s_add_u32 s62, s67, 8192
    buffer_load_dwordx4 v12, s[44:47], s62 offen lds
    s_add_u32 s64, s24, 12
    s_min_u32 s64, s64, 13
    s_lshr_b32 s65, s70, 3
    s_mul_i32 s65, s65, 14
    s_add_u32 s65, s65, s64
    s_and_b32 s66, s70, 7
    s_lshl_b32 s67, s65, 14
    s_lshl_b32 s68, s66, 7
    s_add_u32 s67, s67, s68
    s_add_u32 m0, s71, 6144
    s_add_u32 s62, s67, 0
    buffer_load_dwordx4 v12, s[44:47], s62 offen lds
    s_add_u32 m0, s71, 7168
    s_add_u32 s62, s67, 8192
    buffer_load_dwordx4 v12, s[44:47], s62 offen lds
    v_lshrrev_b32 v12, 2, v1
    v_lshlrev_b32 v12, 10, v12
    v_lshrrev_b32 v13, 4, v1
    v_xor_b32 v13, v13, v1
    v_and_b32 v13, 3, v13
    v_lshl_add_u32 v12, v13, 4, v12
    s_and_b32 s64, s70, 7
    s_lshr_b32 s65, s70, 3
    s_and_b32 s66, s24, 1
    s_lshr_b32 s67, s24, 1
    s_lshl_b32 s68, s64, 6
    s_lshl_b32 s69, s66, 5
    s_add_u32 s68, s68, s69
    s_lshl_b32 s68, s68, 10
    s_lshl_b32 s69, s65, 7
    s_add_u32 s68, s68, s69
    s_lshl_b32 s69, s67, 6
    s_add_u32 s68, s68, s69
    s_lshl_b32 s88, s24, 12
    s_add_u32 s88, s88, 147456
    s_add_u32 m0, s88, 0
    s_add_u32 s62, s68, 0
    buffer_load_dwordx4 v12, s[72:75], s62 offen lds
    s_add_u32 m0, s88, 1024
    s_add_u32 s62, s68, 16384
    buffer_load_dwordx4 v12, s[72:75], s62 offen lds
    s_add_u32 m0, s88, 2048
    s_add_u32 s62, s68, 0
    buffer_load_dwordx4 v12, s[84:87], s62 offen lds
    s_add_u32 m0, s88, 3072
    s_add_u32 s62, s68, 16384
    buffer_load_dwordx4 v12, s[84:87], s62 offen lds
    s_mul_i32 s10, s64, 176
    s_lshl_b32 s11, s65, 3
    s_add_u32 s10, s10, s11
    s_lshl_b32 s11, s67, 2
    s_add_u32 s10, s10, s11
    s_lshl_b32 s10, s10, 1
    s_add_u32 s10, s10, s66
    s_lshl_b32 s10, s10, 10
    s_add_u32 s10, s10, 11534336
    s_mov_b32 s62, 0
parallel_sum__ssm_conv_s5__dense_activation_gelu__prompt_kernel_l_cchk:
    v_xor_b32 v105, s93, v105
    v_xor_b32 v107, s93, v107
    v_xor_b32 v109, s93, v109
    v_xor_b32 v111, s93, v111
    v_xor_b32 v113, s93, v113
    v_xor_b32 v115, s93, v115
    v_xor_b32 v117, s93, v117
    v_xor_b32 v119, s93, v119
    v_or3_b32 v24, v105, v107, v109
    v_or3_b32 v25, v111, v113, v115
    v_or3_b32 v24, v24, v117, v119
    v_or_b32 v24, v24, v25
    v_cmp_ne_u32 s[96:97], 0, v24
    s_nop 2
    s_cmp_eq_u64 s[96:97], 0
    s_cbranch_scc1 parallel_sum__ssm_conv_s5__dense_activation_gelu__prompt_kernel_l_cok
    s_add_u32 s62, s62, 1
    s_cmp_gt_u32 s62, 100000
    s_cbranch_scc1 parallel_sum__ssm_conv_s5__dense_activation_gelu__prompt_kernel_l_cok
    s_sleep 2
    v_lshrrev_b32 v19, 4, v1
    v_and_b32 v20, 15, v1
    v_lshlrev_b32 v21, 10, v19
    v_lshl_add_u32 v21, v20, 4, v21
    s_lshl_b32 s59, s28, 14
    s_lshl_b32 s60, s24, 8
    s_add_u32 s59, s59, s60
    s_add_u32 s59, s59, 14516224
    buffer_load_dwordx4 v[104:107], v21, s[32:35], s59 offen sc1
    s_add_u32 s59, s59, 4096
    buffer_load_dwordx4 v[108:111], v21, s[32:35], s59 offen sc1
    s_add_u32 s59, s59, 4096
    buffer_load_dwordx4 v[112:115], v21, s[32:35], s59 offen sc1
    s_add_u32 s59, s59, 4096
    buffer_load_dwordx4 v[116:119], v21, s[32:35], s59 offen sc1
    s_add_u32 s59, s59, 4096
    s_waitcnt vmcnt(0)
    s_branch parallel_sum__ssm_conv_s5__dense_activation_gelu__prompt_kernel_l_cchk
parallel_sum__ssm_conv_s5__dense_activation_gelu__prompt_kernel_l_cok:
    v_add_f32 v24, v104, v108
    v_add_f32 v25, v106, v110
    v_add_f32 v26, v112, v116
    v_add_f32 v27, v114, v118
    v_add_f32 v24, v24, v26
    v_add_f32 v25, v25, v27
    v_mov_b32 v29, v120
    s_lshl_b32 s54, s31, 8
    s_add_u32 s54, s54, 16384
    v_lshlrev_b32 v12, 3, v2
    v_add_u32 v12, s54, v12
    ds_read_b64 v[110:111], v12
    v_bfe_u32 v13, v1, 2, 2
    v_lshl_add_u32 v14, v3, 3, v13
    v_lshlrev_b32 v14, 7, v14
    v_bfe_u32 v15, v1, 4, 1
    v_lshlrev_b32 v15, 1, v15
    v_bfe_u32 v12, v1, 1, 1
    v_add_u32 v15, v15, v12
    v_lshrrev_b32 v12, 1, v13
    v_lshl_add_u32 v15, v12, 2, v15
    v_lshl_add_u32 v14, v15, 4, v14
    v_and_b32 v12, 1, v1
    v_lshl_add_u32 v8, v12, 3, v14
    v_xor_b32 v11, 64, v8
    v_add_u32 v4, 49152, v8
    v_add_u32 v5, 49152, v11
    v_add_u32 v6, 114688, v8
    v_add_u32 v7, 114688, v11
    v_lshlrev_b32 v9, 4, v1
    v_mov_b32 v104, 0
    v_mov_b32 v105, 0
    v_mov_b32 v106, 0
    v_mov_b32 v107, 0
    s_waitcnt lgkmcnt(0)
    v_rcp_f32 v108, v111
    s_mov_b32 exec_hi, 0
    v_cvt_pk_bf16_f32 v104, -v110, -v110
    v_lshrrev_b32 v105, 16, v111
    s_mov_b32 exec_hi, -1
    v_mul_f32 v109, v108, v108
    v_mul_f32 v109, v109, v108
    v_mul_f32 v109, 0xbdd2d3e8, v109
    v_mul_f32 v108, 0xc0135761, v108
    v_mov_b32 v110, v111
    s_lshl_b32 s60, s27, 1
    s_lshr_b32 s61, s31, 1
    s_add_u32 s60, s60, s61
    s_mul_i32 s60, s60, 360448
    s_and_b32 s61, s31, 1
    s_lshl_b32 s61, s61, 10
    s_add_u32 s60, s60, s61
    s_add_u32 s60, s60, 0
    v_lshlrev_b32 v10, 3, v2
    v_add_u32 v10, 20480, v10
    s_mov_b32 exec_lo, 0
    v_mov_b32 v10, 21760
    s_mov_b32 exec_lo, -1
    v_mov_b32 v102, 0
    v_mov_b32 v103, 0
    s_lshl_b32 s63, s29, 13
    s_add_u32 s63, s63, s60
    s_add_u32 s63, s63, 131072
    ds_read_b64_tr_b16 v[80:81], v4 offset:0
    ds_read_b64_tr_b16 v[82:83], v4 offset:512
    ds_read_b64_tr_b16 v[84:85], v4 offset:2048
    ds_read_b64_tr_b16 v[86:87], v4 offset:2560
    ds_read_b64_tr_b16 v[88:89], v4 offset:4096
    ds_read_b64_tr_b16 v[90:91], v4 offset:4608
    ds_read_b64_tr_b16 v[92:93], v4 offset:6144
    ds_read_b64_tr_b16 v[94:95], v4 offset:6656
    ds_read_b64_tr_b16 v[96:97], v4 offset:8192
    ds_read_b64_tr_b16 v[98:99], v4 offset:8704
    s_waitcnt lgkmcnt(8)
    v_mfma_f32_32x32x16_bf16 v[48:63], v[80:83], a[0:3], 0
    v_mov_b32 v26, v24
    v_mov_b32 v27, v25
    ds_read_b64_tr_b16 v[80:81], v4 offset:10240
    ds_read_b64_tr_b16 v[82:83], v4 offset:10752
    s_waitcnt lgkmcnt(8)
    v_mfma_f32_32x32x16_bf16 v[48:63], v[84:87], a[4:7], v[48:63]
    v_permlane16_swap_b32 v24, v26
    v_permlane16_swap_b32 v25, v27
    ds_read_b64_tr_b16 v[84:85], v4 offset:12288
    ds_read_b64_tr_b16 v[86:87], v4 offset:12800
    s_waitcnt lgkmcnt(8)
    v_mfma_f32_32x32x16_bf16 v[48:63], v[88:91], a[8:11], v[48:63]
    v_add_f32 v24, v24, v26
    v_add_f32 v25, v25, v27
    ds_read_b64_tr_b16 v[88:89], v4 offset:14336
    ds_read_b64_tr_b16 v[90:91], v4 offset:14848
    s_waitcnt lgkmcnt(8)
    v_mfma_f32_32x32x16_bf16 v[48:63], v[92:95], a[12:15], v[48:63]
    v_mov_b32 v26, v24
    v_mov_b32 v27, v25
    ds_read_b64_tr_b16 v[92:93], v4 offset:16384
    ds_read_b64_tr_b16 v[94:95], v4 offset:16896
    s_waitcnt lgkmcnt(8)
    v_mfma_f32_32x32x16_bf16 v[48:63], v[96:99], a[16:19], v[48:63]
    v_permlane32_swap_b32 v24, v26
    v_permlane32_swap_b32 v25, v27
    ds_read_b64_tr_b16 v[96:97], v4 offset:18432
    ds_read_b64_tr_b16 v[98:99], v4 offset:18944
    s_waitcnt lgkmcnt(8)
    v_mfma_f32_32x32x16_bf16 v[48:63], v[80:83], a[20:23], v[48:63]
    v_add_f32 v24, v24, v26
    v_add_f32 v25, v25, v27
    ds_read_b64_tr_b16 v[80:81], v4 offset:20480
    ds_read_b64_tr_b16 v[82:83], v4 offset:20992
    s_waitcnt lgkmcnt(8)
    v_mfma_f32_32x32x16_bf16 v[48:63], v[84:87], a[24:27], v[48:63]
    v_cvt_pk_bf16_f32 v26, v24, v24
    v_and_b32 v26, 0xffff0000, v26
    ds_read_b64_tr_b16 v[84:85], v4 offset:22528
    ds_read_b64_tr_b16 v[86:87], v4 offset:23040
    s_waitcnt lgkmcnt(8)
    v_mfma_f32_32x32x16_bf16 v[48:63], v[88:91], a[28:31], v[48:63]
    v_sub_f32 v26, v24, v26
    v_cvt_pk_bf16_f32 v16, v24, v26
    ds_read_b64_tr_b16 v[88:89], v4 offset:24576
    ds_read_b64_tr_b16 v[90:91], v4 offset:25088
    s_waitcnt lgkmcnt(8)
    v_mfma_f32_32x32x16_bf16 v[48:63], v[92:95], a[32:35], v[48:63]
    v_cvt_pk_bf16_f32 v26, v25, v25
    v_and_b32 v26, 0xffff0000, v26
    ds_read_b64_tr_b16 v[92:93], v4 offset:26624
    ds_read_b64_tr_b16 v[94:95], v4 offset:27136
    s_waitcnt lgkmcnt(8)
    v_mfma_f32_32x32x16_bf16 v[48:63], v[96:99], a[36:39], v[48:63]
    v_sub_f32 v26, v25, v26
    v_cvt_pk_bf16_f32 v18, v25, v26
    ds_read_b64_tr_b16 v[96:97], v4 offset:28672
    ds_read_b64_tr_b16 v[98:99], v4 offset:29184
    s_waitcnt lgkmcnt(8)
    v_mfma_f32_32x32x16_bf16 v[48:63], v[80:83], a[40:43], v[48:63]
    v_and_b32 v17, 0xffff, v29
    v_lshrrev_b32 v19, 16, v29
    ds_read_b64_tr_b16 v[80:81], v4 offset:30720
    ds_read_b64_tr_b16 v[82:83], v4 offset:31232
    s_waitcnt lgkmcnt(8)
    v_mfma_f32_32x32x16_bf16 v[48:63], v[84:87], a[44:47], v[48:63]
    v_and_b32 v28, 15, v1
    v_lshlrev_b32 v28, 4, v28
    ds_read_b64_tr_b16 v[84:85], v4 offset:32768
    ds_read_b64_tr_b16 v[86:87], v4 offset:33280
    s_waitcnt lgkmcnt(8)
    v_mfma_f32_32x32x16_bf16 v[48:63], v[88:91], a[48:51], v[48:63]
    s_lshl_b32 s59, s24, 8
    s_add_u32 s59, s59, 20480
    ds_read_b64_tr_b16 v[88:89], v4 offset:34816
    ds_read_b64_tr_b16 v[90:91], v4 offset:35328
    s_waitcnt lgkmcnt(8)
    v_mfma_f32_32x32x16_bf16 v[48:63], v[92:95], a[52:55], v[48:63]
    v_add_u32 v28, s59, v28
    s_mov_b64 exec, 0xffff
    ds_write_b128 v28, v[16:19]
    s_mov_b64 exec, -1
    ds_read_b64_tr_b16 v[92:93], v4 offset:36864
    ds_read_b64_tr_b16 v[94:95], v4 offset:37376
    s_waitcnt lgkmcnt(9)
    v_mfma_f32_32x32x16_bf16 v[48:63], v[96:99], a[56:59], v[48:63]
    ds_read_b64_tr_b16 v[96:97], v4 offset:38912
    ds_read_b64_tr_b16 v[98:99], v4 offset:39424
    s_waitcnt lgkmcnt(9)
    v_mfma_f32_32x32x16_bf16 v[48:63], v[80:83], a[60:63], v[48:63]
    s_waitcnt vmcnt(0)
    v_bfe_u32 v13, v1, 2, 2
    v_lshl_add_u32 v14, v3, 2, v13
    v_lshlrev_b32 v14, 7, v14
    v_bfe_u32 v15, v1, 4, 1
    v_lshlrev_b32 v15, 1, v15
    v_bfe_u32 v12, v1, 1, 1
    v_add_u32 v15, v15, v12
    v_lshrrev_b32 v12, 1, v13
    v_lshl_add_u32 v15, v12, 2, v15
    v_lshl_add_u32 v14, v15, 4, v14
    v_and_b32 v12, 1, v1
    v_lshl_add_u32 v113, v12, 3, v14
    v_add_u32 v113, s71, v113
    v_xor_b32 v114, 64, v113
    v_bfe_u32 v12, v2, 2, 2
    v_lshlrev_b32 v12, 4, v12
    v_lshl_add_u32 v12, v2, 6, v12
    v_lshl_add_u32 v12, v3, 3, v12
    v_add_u32 v116, s88, v12
    v_xor_b32 v117, 0, v116
    ds_read_b64 v[64:65], v117
    ds_read_b64 v[66:67], v117 offset:2048
    v_xor_b32 v117, 16, v116
    ds_read_b64 v[68:69], v117
    ds_read_b64 v[70:71], v117 offset:2048
    v_xor_b32 v117, 32, v116
    ds_read_b64 v[72:73], v117
    ds_read_b64 v[74:75], v117 offset:2048
    v_xor_b32 v117, 48, v116
    ds_read_b64 v[76:77], v117
    ds_read_b64 v[78:79], v117 offset:2048
    s_add_u32 s64, s24, 0
    s_min_u32 s64, s64, 13
    s_lshr_b32 s65, s70, 3
    s_mul_i32 s65, s65, 14
    s_add_u32 s65, s65, s64
    s_and_b32 s66, s70, 7
    ds_read_b64_tr_b16 v[16:17], v113 offset:0
    ds_read_b64_tr_b16 v[18:19], v113 offset:1024
    ds_read_b64_tr_b16 v[20:21], v114 offset:0
    ds_read_b64_tr_b16 v[22:23], v114 offset:1024
    s_mul_i32 s67, s66, 176
    s_add_u32 s67, s67, s65
    s_add_u32 s67, s67, 64
    s_lshl_b32 s67, s67, 11
    s_add_u32 s67, s67, 11534336
    s_waitcnt lgkmcnt(2)
    buffer_store_dwordx4 v[16:19], v9, s[32:35], s67 offen sc0 sc1
    s_waitcnt lgkmcnt(0)
    buffer_store_dwordx4 v[20:23], v9, s[32:35], s67 offen offset:1024 sc0 sc1
    s_add_u32 s64, s24, 4
    s_min_u32 s64, s64, 13
    s_lshr_b32 s65, s70, 3
    s_mul_i32 s65, s65, 14
    s_add_u32 s65, s65, s64
    s_and_b32 s66, s70, 7
    ds_read_b64_tr_b16 v[24:25], v113 offset:2048
    ds_read_b64_tr_b16 v[26:27], v113 offset:3072
    ds_read_b64_tr_b16 v[28:29], v114 offset:2048
    ds_read_b64_tr_b16 v[30:31], v114 offset:3072
    s_mul_i32 s67, s66, 176
    s_add_u32 s67, s67, s65
    s_add_u32 s67, s67, 64
    s_lshl_b32 s67, s67, 11
    s_add_u32 s67, s67, 11534336
    s_waitcnt lgkmcnt(2)
    buffer_store_dwordx4 v[24:27], v9, s[32:35], s67 offen sc0 sc1
    s_waitcnt lgkmcnt(0)
    buffer_store_dwordx4 v[28:31], v9, s[32:35], s67 offen offset:1024 sc0 sc1
    s_add_u32 s64, s24, 8
    s_min_u32 s64, s64, 13
    s_lshr_b32 s65, s70, 3
    s_mul_i32 s65, s65, 14
    s_add_u32 s65, s65, s64
    s_and_b32 s66, s70, 7
    ds_read_b64_tr_b16 v[16:17], v113 offset:4096
    ds_read_b64_tr_b16 v[18:19], v113 offset:5120
    ds_read_b64_tr_b16 v[20:21], v114 offset:4096
    ds_read_b64_tr_b16 v[22:23], v114 offset:5120
    s_mul_i32 s67, s66, 176
    s_add_u32 s67, s67, s65
    s_add_u32 s67, s67, 64
    s_lshl_b32 s67, s67, 11
    s_add_u32 s67, s67, 11534336
    s_waitcnt lgkmcnt(2)
    buffer_store_dwordx4 v[16:19], v9, s[32:35], s67 offen sc0 sc1
    s_waitcnt lgkmcnt(0)
    buffer_store_dwordx4 v[20:23], v9, s[32:35], s67 offen offset:1024 sc0 sc1
    s_add_u32 s64, s24, 12
    s_min_u32 s64, s64, 13
    s_lshr_b32 s65, s70, 3
    s_mul_i32 s65, s65, 14
    s_add_u32 s65, s65, s64
    s_and_b32 s66, s70, 7
    ds_read_b64_tr_b16 v[24:25], v113 offset:6144
    ds_read_b64_tr_b16 v[26:27], v113 offset:7168
    ds_read_b64_tr_b16 v[28:29], v114 offset:6144
    ds_read_b64_tr_b16 v[30:31], v114 offset:7168
    s_mul_i32 s67, s66, 176
    s_add_u32 s67, s67, s65
    s_add_u32 s67, s67, 64
    s_lshl_b32 s67, s67, 11
    s_add_u32 s67, s67, 11534336
    s_waitcnt lgkmcnt(2)
    buffer_store_dwordx4 v[24:27], v9, s[32:35], s67 offen sc0 sc1
    s_waitcnt lgkmcnt(0)
    buffer_store_dwordx4 v[28:31], v9, s[32:35], s67 offen offset:1024 sc0 sc1
    s_mov_b32 s76, 0x05040100
    s_mov_b32 s77, 0x07060302
    v_perm_b32 v32, v66, v64, s76
    v_perm_b32 v33, v66, v64, s77
    v_perm_b32 v34, v67, v65, s76
    v_perm_b32 v35, v67, v65, s77
    s_add_u32 s11, s10, 0
    buffer_store_dwordx4 v[32:35], v9, s[32:35], s11 offen sc0 sc1
    v_perm_b32 v36, v70, v68, s76
    v_perm_b32 v37, v70, v68, s77
    v_perm_b32 v38, v71, v69, s76
    v_perm_b32 v39, v71, v69, s77
    s_add_u32 s11, s10, 2048
    buffer_store_dwordx4 v[36:39], v9, s[32:35], s11 offen sc0 sc1
    v_perm_b32 v40, v74, v72, s76
    v_perm_b32 v41, v74, v72, s77
    v_perm_b32 v42, v75, v73, s76
    v_perm_b32 v43, v75, v73, s77
    s_add_u32 s11, s10, 4096
    buffer_store_dwordx4 v[40:43], v9, s[32:35], s11 offen sc0 sc1
    v_perm_b32 v44, v78, v76, s76
    v_perm_b32 v45, v78, v76, s77
    v_perm_b32 v46, v79, v77, s76
    v_perm_b32 v47, v79, v77, s77
    s_add_u32 s11, s10, 6144
    buffer_store_dwordx4 v[44:47], v9, s[32:35], s11 offen sc0 sc1
    ds_read_b64_tr_b16 v[80:81], v4 offset:40960
    ds_read_b64_tr_b16 v[82:83], v4 offset:41472
    v_mfma_f32_32x32x16_bf16 v[48:63], v[84:87], a[64:67], v[48:63]
    ds_read_b64_tr_b16 v[84:85], v4 offset:43008
    ds_read_b64_tr_b16 v[86:87], v4 offset:43520
    v_mfma_f32_32x32x16_bf16 v[48:63], v[88:91], a[68:71], v[48:63]
    ds_read_b64_tr_b16 v[88:89], v4 offset:45056
    ds_read_b64_tr_b16 v[90:91], v4 offset:45568
    v_mfma_f32_32x32x16_bf16 v[48:63], v[92:95], a[72:75], v[48:63]
    ds_read_b64_tr_b16 v[92:93], v4 offset:47104
    ds_read_b64_tr_b16 v[94:95], v4 offset:47616
    v_mfma_f32_32x32x16_bf16 v[48:63], v[96:99], a[76:79], v[48:63]
    ds_read_b64_tr_b16 v[96:97], v4 offset:49152
    ds_read_b64_tr_b16 v[98:99], v4 offset:49664
    s_waitcnt lgkmcnt(8)
    v_mfma_f32_32x32x16_bf16 v[48:63], v[80:83], a[80:83], v[48:63]
    ds_read_b64_tr_b16 v[80:81], v4 offset:51200
    ds_read_b64_tr_b16 v[82:83], v4 offset:51712
    s_waitcnt lgkmcnt(8)
    v_mfma_f32_32x32x16_bf16 v[48:63], v[84:87], a[84:87], v[48:63]
    ds_read_b64_tr_b16 v[84:85], v4 offset:53248
    ds_read_b64_tr_b16 v[86:87], v4 offset:53760
    s_waitcnt lgkmcnt(8)
    v_mfma_f32_32x32x16_bf16 v[48:63], v[88:91], a[88:91], v[48:63]
    ds_read_b64_tr_b16 v[88:89], v4 offset:55296
    ds_read_b64_tr_b16 v[90:91], v4 offset:55808
    s_waitcnt lgkmcnt(8)
    v_mfma_f32_32x32x16_bf16 v[48:63], v[92:95], a[92:95], v[48:63]
    s_waitcnt lgkmcnt(0)
    s_barrier
    ds_read_b64_tr_b16 v[92:93], v4 offset:57344
    ds_read_b64_tr_b16 v[94:95], v4 offset:57856
    v_mfma_f32_32x32x16_bf16 v[48:63], v[96:99], a[96:99], v[48:63]
    ds_read_b64 v[100:101], v10 offset:0
    ds_read_b64_tr_b16 v[96:97], v4 offset:59392
    ds_read_b64_tr_b16 v[98:99], v4 offset:59904
    v_mfma_f32_32x32x16_bf16 v[48:63], v[80:83], a[100:103], v[48:63]
    ds_read_b64_tr_b16 v[80:81], v4 offset:61440
    ds_read_b64_tr_b16 v[82:83], v4 offset:61952
    v_mfma_f32_32x32x16_bf16 v[48:63], v[84:87], a[104:107], v[48:63]
    ds_read_b64_tr_b16 v[84:85], v4 offset:63488
    ds_read_b64_tr_b16 v[86:87], v4 offset:64000
    v_mfma_f32_32x32x16_bf16 v[48:63], v[88:91], a[108:111], v[48:63]
    s_waitcnt lgkmcnt(7)
    v_mfma_f32_32x32x16_bf16 v[48:63], v[92:95], a[112:115], v[48:63]
    s_waitcnt lgkmcnt(4)
    v_mfma_f32_32x32x16_bf16 v[48:63], v[96:99], a[116:119], v[48:63]
    s_waitcnt lgkmcnt(2)
    v_mfma_f32_32x32x16_bf16 v[48:63], v[80:83], a[120:123], v[48:63]
    s_waitcnt lgkmcnt(0)
    v_mfma_f32_32x32x16_bf16 v[48:63], v[84:87], a[124:127], v[48:63]
    v_mfma_f32_32x32x16_bf16 v[48:63], v[100:103], v[104:107], v[48:63]
    s_nop 11
    v_mul_f32 v16, v48, v48
    v_mul_f32 v17, v49, v49
    v_mul_f32 v18, v50, v50
    v_mul_f32 v19, v51, v51
    v_fma_f32 v16, v16, v109, v108
    v_fma_f32 v17, v17, v109, v108
    v_fma_f32 v18, v18, v109, v108
    v_fma_f32 v19, v19, v109, v108
    v_mul_f32 v16, v16, v48
    v_mul_f32 v17, v17, v49
    v_mul_f32 v18, v18, v50
    v_mul_f32 v19, v19, v51
    v_exp_f32 v16, v16
    v_exp_f32 v17, v17
    v_exp_f32 v18, v18
    v_exp_f32 v19, v19
    v_fma_f32 v16, v16, v110, v110
    v_fma_f32 v17, v17, v110, v110
    v_fma_f32 v18, v18, v110, v110
    v_fma_f32 v19, v19, v110, v110
    v_rcp_f32 v16, v16
    v_rcp_f32 v17, v17
    v_rcp_f32 v18, v18
    v_rcp_f32 v19, v19
    v_mul_f32 v16, v16, v48
    v_mul_f32 v17, v17, v49
    v_mul_f32 v18, v18, v50
    v_mul_f32 v19, v19, v51
    v_cvt_pk_bf16_f32 v16, v16, v17
    v_cvt_pk_bf16_f32 v17, v18, v19
    v_mul_f32 v20, v52, v52
    v_mul_f32 v21, v53, v53
    v_mul_f32 v22, v54, v54
    v_mul_f32 v23, v55, v55
    v_fma_f32 v20, v20, v109, v108
    v_fma_f32 v21, v21, v109, v108
    v_fma_f32 v22, v22, v109, v108
    v_fma_f32 v23, v23, v109, v108
    v_mul_f32 v20, v20, v52
    v_mul_f32 v21, v21, v53
    v_mul_f32 v22, v22, v54
    v_mul_f32 v23, v23, v55
    v_exp_f32 v20, v20
    v_exp_f32 v21, v21
    v_exp_f32 v22, v22
    v_exp_f32 v23, v23
    v_fma_f32 v20, v20, v110, v110
    v_fma_f32 v21, v21, v110, v110
    v_fma_f32 v22, v22, v110, v110
    v_fma_f32 v23, v23, v110, v110
    v_rcp_f32 v20, v20
    v_rcp_f32 v21, v21
    v_rcp_f32 v22, v22
    v_rcp_f32 v23, v23
    v_mul_f32 v20, v20, v52
    v_mul_f32 v21, v21, v53
    v_mul_f32 v22, v22, v54
    v_mul_f32 v23, v23, v55
    v_cvt_pk_bf16_f32 v20, v20, v21
    v_cvt_pk_bf16_f32 v21, v22, v23
    v_mov_b32 v18, v20
    v_mov_b32 v19, v21
    s_add_u32 s61, s63, 0
    buffer_store_dwordx4 v[16:19], v9, s[32:35], s61 offen sc0 sc1
    v_mul_f32 v24, v56, v56
    v_mul_f32 v25, v57, v57
    v_mul_f32 v26, v58, v58
    v_mul_f32 v27, v59, v59
    v_fma_f32 v24, v24, v109, v108
    v_fma_f32 v25, v25, v109, v108
    v_fma_f32 v26, v26, v109, v108
    v_fma_f32 v27, v27, v109, v108
    v_mul_f32 v24, v24, v56
    v_mul_f32 v25, v25, v57
    v_mul_f32 v26, v26, v58
    v_mul_f32 v27, v27, v59
    v_exp_f32 v24, v24
    v_exp_f32 v25, v25
    v_exp_f32 v26, v26
    v_exp_f32 v27, v27
    v_fma_f32 v24, v24, v110, v110
    v_fma_f32 v25, v25, v110, v110
    v_fma_f32 v26, v26, v110, v110
    v_fma_f32 v27, v27, v110, v110
    v_rcp_f32 v24, v24
    v_rcp_f32 v25, v25
    v_rcp_f32 v26, v26
    v_rcp_f32 v27, v27
    v_mul_f32 v24, v24, v56
    v_mul_f32 v25, v25, v57
    v_mul_f32 v26, v26, v58
    v_mul_f32 v27, v27, v59
    v_cvt_pk_bf16_f32 v24, v24, v25
    v_cvt_pk_bf16_f32 v25, v26, v27
    v_mul_f32 v28, v60, v60
    v_mul_f32 v29, v61, v61
    v_mul_f32 v30, v62, v62
    v_mul_f32 v31, v63, v63
    v_fma_f32 v28, v28, v109, v108
    v_fma_f32 v29, v29, v109, v108
    v_fma_f32 v30, v30, v109, v108
    v_fma_f32 v31, v31, v109, v108
    v_mul_f32 v28, v28, v60
    v_mul_f32 v29, v29, v61
    v_mul_f32 v30, v30, v62
    v_mul_f32 v31, v31, v63
    v_exp_f32 v28, v28
    v_exp_f32 v29, v29
    v_exp_f32 v30, v30
    v_exp_f32 v31, v31
    v_fma_f32 v28, v28, v110, v110
    v_fma_f32 v29, v29, v110, v110
    v_fma_f32 v30, v30, v110, v110
    v_fma_f32 v31, v31, v110, v110
    v_rcp_f32 v28, v28
    v_rcp_f32 v29, v29
    v_rcp_f32 v30, v30
    v_rcp_f32 v31, v31
    v_mul_f32 v28, v28, v60
    v_mul_f32 v29, v29, v61
    v_mul_f32 v30, v30, v62
    v_mul_f32 v31, v31, v63
    v_cvt_pk_bf16_f32 v28, v28, v29
    v_cvt_pk_bf16_f32 v29, v30, v31
    v_mov_b32 v26, v28
    v_mov_b32 v27, v29
    s_add_u32 s61, s63, 2048
    buffer_store_dwordx4 v[24:27], v9, s[32:35], s61 offen sc0 sc1
    s_waitcnt vmcnt(2)
    s_and_b32 s64, s70, 7
    s_lshl_b32 s64, s64, 5
    s_lshr_b32 s65, s70, 3
    s_lshl_b32 s65, s65, 2
    s_add_u32 s64, s64, s65
    s_add_u32 s64, s64, s24
    s_lshl_b32 s64, s64, 2
    s_add_u32 s64, s64, 14910720
    s_mov_b64 exec, 1
    v_mov_b32 v12, s93
    v_mov_b32 v13, s64
    buffer_store_dword v12, v13, s[32:35], 0 offen sc1
    s_mov_b64 exec, -1
parallel_sum__ssm_conv_s5__dense_activation_gelu__prompt_kernel_P2:
    s_setprio 0
    s_load_dwordx2 s[4:5], s[0:1], 0
    s_load_dwordx2 s[6:7], s[0:1], 64
    s_load_dwordx4 s[8:11], s[0:1], 104
    s_mov_b32 s12, s22
    s_mov_b32 s13, s23
    s_mov_b32 s14, s25
    s_lshl_b32 s17, s27, 1
    s_lshr_b32 s18, s28, 3
    s_add_u32 s17, s17, s18
    s_and_b32 s18, s28, 7
    v_mov_b32 v2, v1
    v_lshlrev_b32 v3, 4, v2
    s_waitcnt vmcnt(0) lgkmcnt(0)
    s_barrier
    s_cmp_lg_u32 s14, 1
    s_cbranch_scc1 parallel_sum__ssm_conv_s5__dense_activation_gelu__prompt_kernel_p2nb
    v_readfirstlane_b32 s19, v114
    s_nop 2
    s_cmp_lg_u32 s19, 255
    s_cbranch_scc1 parallel_sum__ssm_conv_s5__dense_activation_gelu__prompt_kernel_p2nb
    s_mov_b64 exec, 1
    v_mov_b32 v4, s93
    v_mov_b32 v5, 14909440
    buffer_store_dword v4, v5, s[32:35], 0 offen
    s_mov_b64 exec, -1
parallel_sum__ssm_conv_s5__dense_activation_gelu__prompt_kernel_p2nb:
    s_cmp_lg_u32 s14, 0
    s_cbranch_scc1 parallel_sum__ssm_conv_s5__dense_activation_gelu__prompt_kernel_p2nf
    s_mov_b64 exec, 1
    v_mov_b32 v4, s93
    s_lshl_b32 s19, s27, 4
    s_add_u32 s19, s19, s28
    s_lshl_b32 s19, s19, 2
    s_add_u32 s19, s19, 14909696
    v_mov_b32 v5, s19
    buffer_store_dword v4, v5, s[32:35], 0 offen sc1
    s_mov_b64 exec, -1
parallel_sum__ssm_conv_s5__dense_activation_gelu__prompt_kernel_p2nf:
    s_cmp_lg_u32 s14, 4
    s_cbranch_scc1 parallel_sum__ssm_conv_s5__dense_activation_gelu__prompt_kernel_p2np
    s_lshl_b32 s19, s18, 7
    s_add_u32 s19, s19, 14910720
    v_lshlrev_b32 v5, 2, v2
    v_add_u32 v5, s19, v5
    s_mov_b64 exec, 0xffffffff
    s_mov_b32 s21, 0
parallel_sum__ssm_conv_s5__dense_activation_gelu__prompt_kernel_p2pw:
    buffer_load_dword v7, v5, s[32:35], 0 offen sc1
    s_waitcnt vmcnt(0)
    v_cmp_ne_u32 s[96:97], s93, v7
    s_nop 2
    s_cmp_eq_u64 s[96:97], 0
    s_cbranch_scc1 parallel_sum__ssm_conv_s5__dense_activation_gelu__prompt_kernel_p2pw_d
    s_add_u32 s21, s21, 1
    s_cmp_gt_u32 s21, 200000
    s_cbranch_scc1 parallel_sum__ssm_conv_s5__dense_activation_gelu__prompt_kernel_p2pw_d
    s_sleep 2
    s_branch parallel_sum__ssm_conv_s5__dense_activation_gelu__prompt_kernel_p2pw
parallel_sum__ssm_conv_s5__dense_activation_gelu__prompt_kernel_p2pw_d:
    s_mov_b64 exec, -1
parallel_sum__ssm_conv_s5__dense_activation_gelu__prompt_kernel_p2np:
    s_waitcnt lgkmcnt(0)
    s_mul_i32 s19, s17, 360448
    s_add_u32 s19, s19, 0
    s_add_u32 s48, s12, s19
    s_addc_u32 s49, s13, 0
    s_mov_b32 s64, s48
    s_and_b32 s65, s49, 0xffff
    s_mov_b32 s66, 360448
    s_mov_b32 s67, 0x00020000
    s_mul_i32 s19, s18, 360448
    s_add_u32 s19, s19, 11534336
    s_add_u32 s48, s12, s19
    s_addc_u32 s49, s13, 0
    s_mov_b32 s68, s48
    s_and_b32 s69, s49, 0xffff
    s_mov_b32 s70, 360448
    s_mov_b32 s71, 0x00020000
    s_and_b32 s15, s14, 3
    s_mul_i32 s57, s15, 90112
    s_mul_i32 s58, s15, 40960
    s_barrier
    s_cmp_lt_u32 s14, 4
    s_cbranch_scc1 parallel_sum__ssm_conv_s5__dense_activation_gelu__prompt_kernel_p2C
    s_add_u32 m0, s58, 0
    s_add_u32 s59, s57, 0
    buffer_load_dwordx4 v3, s[68:71], s59 offen lds
    s_add_u32 m0, s58, 1024
    s_add_u32 s59, s57, 1024
    buffer_load_dwordx4 v3, s[68:71], s59 offen lds
    s_add_u32 m0, s58, 2048
    s_add_u32 s59, s57, 2048
    buffer_load_dwordx4 v3, s[68:71], s59 offen lds
    s_add_u32 m0, s58, 3072
    s_add_u32 s59, s57, 3072
    buffer_load_dwordx4 v3, s[68:71], s59 offen lds
    s_add_u32 m0, s58, 8192
    s_add_u32 s59, s57, 8192
    buffer_load_dwordx4 v3, s[68:71], s59 offen lds
    s_add_u32 m0, s58, 9216
    s_add_u32 s59, s57, 9216
    buffer_load_dwordx4 v3, s[68:71], s59 offen lds
    s_add_u32 m0, s58, 10240
    s_add_u32 s59, s57, 10240
    buffer_load_dwordx4 v3, s[68:71], s59 offen lds
    s_add_u32 m0, s58, 11264
    s_add_u32 s59, s57, 11264
    buffer_load_dwordx4 v3, s[68:71], s59 offen lds
    s_add_u32 m0, s58, 16384
    s_add_u32 s59, s57, 16384
    buffer_load_dwordx4 v3, s[68:71], s59 offen lds
    s_add_u32 m0, s58, 17408
    s_add_u32 s59, s57, 17408
    buffer_load_dwordx4 v3, s[68:71], s59 offen lds
    s_add_u32 m0, s58, 18432
    s_add_u32 s59, s57, 18432
    buffer_load_dwordx4 v3, s[68:71], s59 offen lds
    s_add_u32 m0, s58, 19456
    s_add_u32 s59, s57, 19456
    buffer_load_dwordx4 v3, s[68:71], s59 offen lds
    s_cmp_lg_u32 s14, 4
    s_cbranch_scc1 parallel_sum__ssm_conv_s5__dense_activation_gelu__prompt_kernel_p2nh
    s_lshl_b32 s19, s27, 6
    s_add_u32 s19, s19, 14909696
    v_lshlrev_b32 v5, 2, v2
    v_add_u32 v5, s19, v5
    s_mov_b64 exec, 0xffff
    s_mov_b32 s21, 0
parallel_sum__ssm_conv_s5__dense_activation_gelu__prompt_kernel_p2ph:
    buffer_load_dword v7, v5, s[32:35], 0 offen sc1
    s_waitcnt vmcnt(0)
    v_cmp_ne_u32 s[96:97], s93, v7
    s_nop 2
    s_cmp_eq_u64 s[96:97], 0
    s_cbranch_scc1 parallel_sum__ssm_conv_s5__dense_activation_gelu__prompt_kernel_p2ph_d
    s_add_u32 s21, s21, 1
    s_cmp_gt_u32 s21, 200000
    s_cbranch_scc1 parallel_sum__ssm_conv_s5__dense_activation_gelu__prompt_kernel_p2ph_d
    s_sleep 2
    s_branch parallel_sum__ssm_conv_s5__dense_activation_gelu__prompt_kernel_p2ph
parallel_sum__ssm_conv_s5__dense_activation_gelu__prompt_kernel_p2ph_d:
    s_mov_b64 exec, -1
parallel_sum__ssm_conv_s5__dense_activation_gelu__prompt_kernel_p2nh:
    s_barrier
    s_add_u32 m0, s58, 24576
    s_add_u32 s59, s57, 0
    buffer_load_dwordx4 v3, s[64:67], s59 offen lds
    s_add_u32 m0, s58, 25600
    s_add_u32 s59, s57, 1024
    buffer_load_dwordx4 v3, s[64:67], s59 offen lds
    s_add_u32 m0, s58, 26624
    s_add_u32 s59, s57, 2048
    buffer_load_dwordx4 v3, s[64:67], s59 offen lds
    s_add_u32 m0, s58, 27648
    s_add_u32 s59, s57, 3072
    buffer_load_dwordx4 v3, s[64:67], s59 offen lds
    s_add_u32 m0, s58, 28672
    s_add_u32 s59, s57, 4096
    buffer_load_dwordx4 v3, s[64:67], s59 offen lds
    s_add_u32 m0, s58, 29696
    s_add_u32 s59, s57, 5120
    buffer_load_dwordx4 v3, s[64:67], s59 offen lds
    s_add_u32 m0, s58, 30720
    s_add_u32 s59, s57, 6144
    buffer_load_dwordx4 v3, s[64:67], s59 offen lds
    s_add_u32 m0, s58, 31744
    s_add_u32 s59, s57, 7168
    buffer_load_dwordx4 v3, s[64:67], s59 offen lds
    s_add_u32 m0, s58, 32768
    s_add_u32 s59, s57, 8192
    buffer_load_dwordx4 v3, s[64:67], s59 offen lds
    s_add_u32 m0, s58, 33792
    s_add_u32 s59, s57, 9216
    buffer_load_dwordx4 v3, s[64:67], s59 offen lds
    s_add_u32 m0, s58, 34816
    s_add_u32 s59, s57, 10240
    buffer_load_dwordx4 v3, s[64:67], s59 offen lds
    s_add_u32 m0, s58, 35840
    s_add_u32 s59, s57, 11264
    buffer_load_dwordx4 v3, s[64:67], s59 offen lds
    s_waitcnt vmcnt(8)
    s_barrier
    s_add_u32 m0, s58, 36864
    s_add_u32 s59, s57, 12288
    buffer_load_dwordx4 v3, s[64:67], s59 offen lds
    s_add_u32 m0, s58, 37888
    s_add_u32 s59, s57, 13312
    buffer_load_dwordx4 v3, s[64:67], s59 offen lds
    s_add_u32 m0, s58, 38912
    s_add_u32 s59, s57, 14336
    buffer_load_dwordx4 v3, s[64:67], s59 offen lds
    s_add_u32 m0, s58, 39936
    s_add_u32 s59, s57, 15360
    buffer_load_dwordx4 v3, s[64:67], s59 offen lds
    s_waitcnt vmcnt(8)
    s_barrier
    s_add_u32 m0, s58, 24576
    s_add_u32 s59, s57, 16384
    buffer_load_dwordx4 v3, s[64:67], s59 offen lds
    s_add_u32 m0, s58, 25600
    s_add_u32 s59, s57, 17408
    buffer_load_dwordx4 v3, s[64:67], s59 offen lds
    s_add_u32 m0, s58, 26624
    s_add_u32 s59, s57, 18432
    buffer_load_dwordx4 v3, s[64:67], s59 offen lds
    s_add_u32 m0, s58, 27648
    s_add_u32 s59, s57, 19456
    buffer_load_dwordx4 v3, s[64:67], s59 offen lds
    s_waitcnt vmcnt(8)
    s_barrier
    s_add_u32 m0, s58, 28672
    s_add_u32 s59, s57, 20480
    buffer_load_dwordx4 v3, s[64:67], s59 offen lds
    s_add_u32 m0, s58, 29696
    s_add_u32 s59, s57, 21504
    buffer_load_dwordx4 v3, s[64:67], s59 offen lds
    s_add_u32 m0, s58, 30720
    s_add_u32 s59, s57, 22528
    buffer_load_dwordx4 v3, s[64:67], s59 offen lds
    s_add_u32 m0, s58, 31744
    s_add_u32 s59, s57, 23552
    buffer_load_dwordx4 v3, s[64:67], s59 offen lds
    s_waitcnt vmcnt(8)
    s_barrier
    s_add_u32 m0, s58, 32768
    s_add_u32 s59, s57, 24576
    buffer_load_dwordx4 v3, s[64:67], s59 offen lds
    s_add_u32 m0, s58, 33792
    s_add_u32 s59, s57, 25600
    buffer_load_dwordx4 v3, s[64:67], s59 offen lds
    s_add_u32 m0, s58, 34816
    s_add_u32 s59, s57, 26624
    buffer_load_dwordx4 v3, s[64:67], s59 offen lds
    s_add_u32 m0, s58, 35840
    s_add_u32 s59, s57, 27648
    buffer_load_dwordx4 v3, s[64:67], s59 offen lds
    s_waitcnt vmcnt(8)
    s_barrier
    s_add_u32 m0, s58, 36864
    s_add_u32 s59, s57, 28672
    buffer_load_dwordx4 v3, s[64:67], s59 offen lds
    s_add_u32 m0, s58, 37888
    s_add_u32 s59, s57, 29696
    buffer_load_dwordx4 v3, s[64:67], s59 offen lds
    s_add_u32 m0, s58, 38912
    s_add_u32 s59, s57, 30720
    buffer_load_dwordx4 v3, s[64:67], s59 offen lds
    s_add_u32 m0, s58, 39936
    s_add_u32 s59, s57, 31744
    buffer_load_dwordx4 v3, s[64:67], s59 offen lds
    s_waitcnt vmcnt(8)
    s_barrier
    s_add_u32 m0, s58, 24576
    s_add_u32 s59, s57, 32768
    buffer_load_dwordx4 v3, s[64:67], s59 offen lds
    s_add_u32 m0, s58, 25600
    s_add_u32 s59, s57, 33792
    buffer_load_dwordx4 v3, s[64:67], s59 offen lds
    s_add_u32 m0, s58, 26624
    s_add_u32 s59, s57, 34816
    buffer_load_dwordx4 v3, s[64:67], s59 offen lds
    s_add_u32 m0, s58, 27648
    s_add_u32 s59, s57, 35840
    buffer_load_dwordx4 v3, s[64:67], s59 offen lds
    s_waitcnt vmcnt(8)
    s_barrier
    s_add_u32 m0, s58, 28672
    s_add_u32 s59, s57, 36864
    buffer_load_dwordx4 v3, s[64:67], s59 offen lds
    s_add_u32 m0, s58, 29696
    s_add_u32 s59, s57, 37888
    buffer_load_dwordx4 v3, s[64:67], s59 offen lds
    s_add_u32 m0, s58, 30720
    s_add_u32 s59, s57, 38912
    buffer_load_dwordx4 v3, s[64:67], s59 offen lds
    s_add_u32 m0, s58, 31744
    s_add_u32 s59, s57, 39936
    buffer_load_dwordx4 v3, s[64:67], s59 offen lds
    s_waitcnt vmcnt(8)
    s_barrier
    s_add_u32 m0, s58, 32768
    s_add_u32 s59, s57, 40960
    buffer_load_dwordx4 v3, s[64:67], s59 offen lds
    s_add_u32 m0, s58, 33792
    s_add_u32 s59, s57, 41984
    buffer_load_dwordx4 v3, s[64:67], s59 offen lds
    s_add_u32 m0, s58, 34816
    s_add_u32 s59, s57, 43008
    buffer_load_dwordx4 v3, s[64:67], s59 offen lds
    s_add_u32 m0, s58, 35840
    s_add_u32 s59, s57, 44032
    buffer_load_dwordx4 v3, s[64:67], s59 offen lds
    s_waitcnt vmcnt(8)
    s_barrier
    s_add_u32 m0, s58, 36864
    s_add_u32 s59, s57, 45056
    buffer_load_dwordx4 v3, s[64:67], s59 offen lds
    s_add_u32 m0, s58, 37888
    s_add_u32 s59, s57, 46080
    buffer_load_dwordx4 v3, s[64:67], s59 offen lds
    s_add_u32 m0, s58, 38912
    s_add_u32 s59, s57, 47104
    buffer_load_dwordx4 v3, s[64:67], s59 offen lds
    s_add_u32 m0, s58, 39936
    s_add_u32 s59, s57, 48128
    buffer_load_dwordx4 v3, s[64:67], s59 offen lds
    s_waitcnt vmcnt(8)
    s_barrier
    s_add_u32 m0, s58, 24576
    s_add_u32 s59, s57, 49152
    buffer_load_dwordx4 v3, s[64:67], s59 offen lds
    s_add_u32 m0, s58, 25600
    s_add_u32 s59, s57, 50176
    buffer_load_dwordx4 v3, s[64:67], s59 offen lds
    s_add_u32 m0, s58, 26624
    s_add_u32 s59, s57, 51200
    buffer_load_dwordx4 v3, s[64:67], s59 offen lds
    s_add_u32 m0, s58, 27648
    s_add_u32 s59, s57, 52224
    buffer_load_dwordx4 v3, s[64:67], s59 offen lds
    s_waitcnt vmcnt(8)
    s_barrier
    s_add_u32 m0, s58, 28672
    s_add_u32 s59, s57, 53248
    buffer_load_dwordx4 v3, s[64:67], s59 offen lds
    s_add_u32 m0, s58, 29696
    s_add_u32 s59, s57, 54272
    buffer_load_dwordx4 v3, s[64:67], s59 offen lds
    s_add_u32 m0, s58, 30720
    s_add_u32 s59, s57, 55296
    buffer_load_dwordx4 v3, s[64:67], s59 offen lds
    s_add_u32 m0, s58, 31744
    s_add_u32 s59, s57, 56320
    buffer_load_dwordx4 v3, s[64:67], s59 offen lds
    s_waitcnt vmcnt(8)
    s_barrier
    s_add_u32 m0, s58, 32768
    s_add_u32 s59, s57, 57344
    buffer_load_dwordx4 v3, s[64:67], s59 offen lds
    s_add_u32 m0, s58, 33792
    s_add_u32 s59, s57, 58368
    buffer_load_dwordx4 v3, s[64:67], s59 offen lds
    s_add_u32 m0, s58, 34816
    s_add_u32 s59, s57, 59392
    buffer_load_dwordx4 v3, s[64:67], s59 offen lds
    s_add_u32 m0, s58, 35840
    s_add_u32 s59, s57, 60416
    buffer_load_dwordx4 v3, s[64:67], s59 offen lds
    s_waitcnt vmcnt(8)
    s_barrier
    s_add_u32 m0, s58, 36864
    s_add_u32 s59, s57, 61440
    buffer_load_dwordx4 v3, s[64:67], s59 offen lds
    s_add_u32 m0, s58, 37888
    s_add_u32 s59, s57, 62464
    buffer_load_dwordx4 v3, s[64:67], s59 offen lds
    s_add_u32 m0, s58, 38912
    s_add_u32 s59, s57, 63488
    buffer_load_dwordx4 v3, s[64:67], s59 offen lds
    s_add_u32 m0, s58, 39936
    s_add_u32 s59, s57, 64512
    buffer_load_dwordx4 v3, s[64:67], s59 offen lds
    s_waitcnt vmcnt(8)
    s_barrier
    s_add_u32 m0, s58, 24576
    s_add_u32 s59, s57, 65536
    buffer_load_dwordx4 v3, s[64:67], s59 offen lds
    s_add_u32 m0, s58, 25600
    s_add_u32 s59, s57, 66560
    buffer_load_dwordx4 v3, s[64:67], s59 offen lds
    s_add_u32 m0, s58, 26624
    s_add_u32 s59, s57, 67584
    buffer_load_dwordx4 v3, s[64:67], s59 offen lds
    s_add_u32 m0, s58, 27648
    s_add_u32 s59, s57, 68608
    buffer_load_dwordx4 v3, s[64:67], s59 offen lds
    s_waitcnt vmcnt(8)
    s_barrier
    s_add_u32 m0, s58, 28672
    s_add_u32 s59, s57, 69632
    buffer_load_dwordx4 v3, s[64:67], s59 offen lds
    s_add_u32 m0, s58, 29696
    s_add_u32 s59, s57, 70656
    buffer_load_dwordx4 v3, s[64:67], s59 offen lds
    s_add_u32 m0, s58, 30720
    s_add_u32 s59, s57, 71680
    buffer_load_dwordx4 v3, s[64:67], s59 offen lds
    s_add_u32 m0, s58, 31744
    s_add_u32 s59, s57, 72704
    buffer_load_dwordx4 v3, s[64:67], s59 offen lds
    s_waitcnt vmcnt(8)
    s_barrier
    s_add_u32 m0, s58, 32768
    s_add_u32 s59, s57, 73728
    buffer_load_dwordx4 v3, s[64:67], s59 offen lds
    s_add_u32 m0, s58, 33792
    s_add_u32 s59, s57, 74752
    buffer_load_dwordx4 v3, s[64:67], s59 offen lds
    s_add_u32 m0, s58, 34816
    s_add_u32 s59, s57, 75776
    buffer_load_dwordx4 v3, s[64:67], s59 offen lds
    s_add_u32 m0, s58, 35840
    s_add_u32 s59, s57, 76800
    buffer_load_dwordx4 v3, s[64:67], s59 offen lds
    s_waitcnt vmcnt(8)
    s_barrier
    s_add_u32 m0, s58, 36864
    s_add_u32 s59, s57, 77824
    buffer_load_dwordx4 v3, s[64:67], s59 offen lds
    s_add_u32 m0, s58, 37888
    s_add_u32 s59, s57, 78848
    buffer_load_dwordx4 v3, s[64:67], s59 offen lds
    s_add_u32 m0, s58, 38912
    s_add_u32 s59, s57, 79872
    buffer_load_dwordx4 v3, s[64:67], s59 offen lds
    s_add_u32 m0, s58, 39936
    s_add_u32 s59, s57, 80896
    buffer_load_dwordx4 v3, s[64:67], s59 offen lds
    s_waitcnt vmcnt(8)
    s_barrier
    s_add_u32 m0, s58, 24576
    s_add_u32 s59, s57, 81920
    buffer_load_dwordx4 v3, s[64:67], s59 offen lds
    s_add_u32 m0, s58, 25600
    s_add_u32 s59, s57, 82944
    buffer_load_dwordx4 v3, s[64:67], s59 offen lds
    s_add_u32 m0, s58, 26624
    s_add_u32 s59, s57, 83968
    buffer_load_dwordx4 v3, s[64:67], s59 offen lds
    s_add_u32 m0, s58, 27648
    s_add_u32 s59, s57, 84992
    buffer_load_dwordx4 v3, s[64:67], s59 offen lds
    s_waitcnt vmcnt(8)
    s_barrier
    s_add_u32 m0, s58, 28672
    s_add_u32 s59, s57, 86016
    buffer_load_dwordx4 v3, s[64:67], s59 offen lds
    s_add_u32 m0, s58, 29696
    s_add_u32 s59, s57, 87040
    buffer_load_dwordx4 v3, s[64:67], s59 offen lds
    s_add_u32 m0, s58, 30720
    s_add_u32 s59, s57, 88064
    buffer_load_dwordx4 v3, s[64:67], s59 offen lds
    s_add_u32 m0, s58, 31744
    s_add_u32 s59, s57, 89088
    buffer_load_dwordx4 v3, s[64:67], s59 offen lds
    s_waitcnt vmcnt(8)
    s_barrier
    s_waitcnt vmcnt(4)
    s_barrier
    s_waitcnt vmcnt(0)
    s_barrier
    s_barrier
    s_endpgm
parallel_sum__ssm_conv_s5__dense_activation_gelu__prompt_kernel_p2C:
    s_add_u32 m0, s58, 4096
    s_add_u32 s59, s57, 4096
    buffer_load_dwordx4 v3, s[68:71], s59 offen lds
    s_add_u32 m0, s58, 5120
    s_add_u32 s59, s57, 5120
    buffer_load_dwordx4 v3, s[68:71], s59 offen lds
    s_add_u32 m0, s58, 6144
    s_add_u32 s59, s57, 6144
    buffer_load_dwordx4 v3, s[68:71], s59 offen lds
    s_add_u32 m0, s58, 7168
    s_add_u32 s59, s57, 7168
    buffer_load_dwordx4 v3, s[68:71], s59 offen lds
    s_add_u32 m0, s58, 12288
    s_add_u32 s59, s57, 12288
    buffer_load_dwordx4 v3, s[68:71], s59 offen lds
    s_add_u32 m0, s58, 13312
    s_add_u32 s59, s57, 13312
    buffer_load_dwordx4 v3, s[68:71], s59 offen lds
    s_add_u32 m0, s58, 14336
    s_add_u32 s59, s57, 14336
    buffer_load_dwordx4 v3, s[68:71], s59 offen lds
    s_add_u32 m0, s58, 15360
    s_add_u32 s59, s57, 15360
    buffer_load_dwordx4 v3, s[68:71], s59 offen lds
    s_add_u32 m0, s58, 20480
    s_add_u32 s59, s57, 20480
    buffer_load_dwordx4 v3, s[68:71], s59 offen lds
    s_add_u32 m0, s58, 21504
    s_add_u32 s59, s57, 21504
    buffer_load_dwordx4 v3, s[68:71], s59 offen lds
    s_add_u32 m0, s58, 22528
    s_add_u32 s59, s57, 22528
    buffer_load_dwordx4 v3, s[68:71], s59 offen lds
    s_add_u32 m0, s58, 23552
    s_add_u32 s59, s57, 23552
    buffer_load_dwordx4 v3, s[68:71], s59 offen lds
    v_add_u32 v4, s58, v3
    s_lshl_b32 s19, s17, 16
    s_lshl_b32 s50, s18, 7
    s_add_u32 s19, s19, s50
    s_add_u32 s48, s4, s19
    s_addc_u32 s49, s5, 0
    s_mov_b32 s28, s48
    s_and_b32 s29, s49, 0xffff
    s_mov_b32 s30, 65536
    s_mov_b32 s31, 0x00020000
    s_sub_u32 s30, 65536, s50
    s_lshl_b32 s19, s17, 9
    s_add_u32 s19, s19, 14417920
    s_add_u32 s48, s12, s19
    s_addc_u32 s49, s13, 0
    s_mov_b32 s32, s48
    s_and_b32 s33, s49, 0xffff
    s_mov_b32 s34, 512
    s_mov_b32 s35, 0x00020000
    s_add_u32 s48, s6, s50
    s_addc_u32 s49, s7, 0
    s_mov_b32 s36, s48
    s_and_b32 s37, s49, 0xffff
    s_mov_b32 s38, 128
    s_mov_b32 s39, 0x00020000
    s_add_u32 s48, s8, s50
    s_addc_u32 s49, s9, 0
    s_mov_b32 s40, s48
    s_and_b32 s41, s49, 0xffff
    s_mov_b32 s42, 128
    s_mov_b32 s43, 0x00020000
    s_lshl_b32 s19, s17, 17
    s_lshl_b32 s51, s18, 8
    s_add_u32 s19, s19, s51
    s_add_u32 s48, s10, s19
    s_addc_u32 s49, s11, 0
    s_mov_b32 s44, s48
    s_and_b32 s45, s49, 0xffff
    s_mov_b32 s46, 131072
    s_mov_b32 s47, 0x00020000
    s_sub_u32 s46, 131072, s51
    v_lshrrev_b32 v5, 4, v2
    v_and_b32 v6, 15, v2
    s_lshl_b32 s52, s14, 4
    v_add_u32 v7, s52, v5
    v_lshlrev_b32 v8, 10, v7
    v_lshl_add_u32 v8, v6, 3, v8
    v_lshlrev_b32 v9, 3, v7
    v_lshlrev_b32 v10, 3, v6
    v_lshlrev_b32 v11, 11, v7
    v_lshl_add_u32 v11, v6, 4, v11
    s_mov_b32 s54, 0
    buffer_load_dwordx2 v[40:41], v8, s[28:31], s54 offen
    s_mov_b32 s54, 4096
    buffer_load_dwordx2 v[42:43], v8, s[28:31], s54 offen
    s_mov_b32 s54, 8192
    buffer_load_dwordx2 v[44:45], v8, s[28:31], s54 offen
    s_mov_b32 s54, 12288
    buffer_load_dwordx2 v[46:47], v8, s[28:31], s54 offen
    buffer_load_dwordx2 v[56:57], v10, s[36:39], 0 offen
    buffer_load_dwordx2 v[58:59], v10, s[40:43], 0 offen
    v_and_b32 v74, 31, v2
    v_lshrrev_b32 v75, 5, v2
    v_bfe_u32 v76, v74, 2, 1
    v_lshlrev_b32 v77, 4, v76
    v_lshrrev_b32 v78, 3, v74
    v_lshl_add_u32 v77, v78, 2, v77
    v_and_b32 v78, 3, v74
    v_add_u32 v77, v77, v78
    v_lshl_add_u32 v78, v76, 2, v78
    v_lshlrev_b32 v77, 8, v77
    v_add_u32 v77, s58, v77
    v_add_u32 v79, 0, v75
    v_xor_b32 v79, v79, v78
    v_lshl_add_u32 v28, v79, 4, v77
    v_add_u32 v79, 2, v75
    v_xor_b32 v79, v79, v78
    v_lshl_add_u32 v29, v79, 4, v77
    v_add_u32 v79, 4, v75
    v_xor_b32 v79, v79, v78
    v_lshl_add_u32 v30, v79, 4, v77
    v_add_u32 v79, 6, v75
    v_xor_b32 v79, v79, v78
    v_lshl_add_u32 v31, v79, 4, v77
    s_and_b32 s56, s14, 1
    s_lshl_b32 s56, s56, 2
    v_or_b32 v79, s56, v5
    v_xor_b32 v79, v79, v6
    v_lshlrev_b32 v32, 8, v7
    v_lshl_add_u32 v32, v79, 4, v32
    v_add_u32 v33, 81920, v32
    s_barrier
    buffer_load_dwordx2 v[48:49], v9, s[32:35], 0 offen offset:0
    buffer_load_dwordx2 v[50:51], v9, s[32:35], 0 offen offset:32
    buffer_load_dwordx2 v[52:53], v9, s[32:35], 0 offen offset:64
    buffer_load_dwordx2 v[54:55], v9, s[32:35], 0 offen offset:96
    s_waitcnt vmcnt(5)
    v_lshlrev_b32 v60, 16, v56
    v_and_b32 v61, 0xffff0000, v56
    v_lshlrev_b32 v62, 16, v57
    v_and_b32 v63, 0xffff0000, v57
    s_waitcnt vmcnt(4)
    v_lshlrev_b32 v64, 16, v58
    v_and_b32 v65, 0xffff0000, v58
    v_lshlrev_b32 v66, 16, v59
    v_and_b32 v67, 0xffff0000, v59
    v_lshlrev_b32 v12, 16, v40
    v_and_b32 v13, 0xffff0000, v40
    v_lshlrev_b32 v14, 16, v41
    v_and_b32 v15, 0xffff0000, v41
    s_waitcnt vmcnt(3)
    v_sub_f32 v68, v12, v48
    v_sub_f32 v69, v13, v48
    v_sub_f32 v70, v14, v48
    v_sub_f32 v71, v15, v48
    v_cvt_pk_bf16_f32 v72, v68, v69
    v_cvt_pk_bf16_f32 v73, v70, v71
    v_lshlrev_b32 v68, 16, v72
    v_and_b32 v69, 0xffff0000, v72
    v_lshlrev_b32 v70, 16, v73
    v_and_b32 v71, 0xffff0000, v73
    v_mul_f32 v68, v68, v49
    v_mul_f32 v69, v69, v49
    v_mul_f32 v70, v70, v49
    v_mul_f32 v71, v71, v49
    v_cvt_pk_bf16_f32 v72, v68, v69
    v_cvt_pk_bf16_f32 v73, v70, v71
    v_lshlrev_b32 v68, 16, v72
    v_and_b32 v69, 0xffff0000, v72
    v_lshlrev_b32 v70, 16, v73
    v_and_b32 v71, 0xffff0000, v73
    v_mul_f32 v68, v68, v60
    v_mul_f32 v69, v69, v61
    v_mul_f32 v70, v70, v62
    v_mul_f32 v71, v71, v63
    v_cvt_pk_bf16_f32 v72, v68, v69
    v_cvt_pk_bf16_f32 v73, v70, v71
    v_lshlrev_b32 v68, 16, v72
    v_and_b32 v69, 0xffff0000, v72
    v_lshlrev_b32 v70, 16, v73
    v_and_b32 v71, 0xffff0000, v73
    v_add_f32 v12, v12, v68
    v_add_f32 v12, v12, v64
    v_add_f32 v13, v13, v69
    v_add_f32 v13, v13, v65
    v_add_f32 v14, v14, v70
    v_add_f32 v14, v14, v66
    v_add_f32 v15, v15, v71
    v_add_f32 v15, v15, v67
    v_lshlrev_b32 v16, 16, v42
    v_and_b32 v17, 0xffff0000, v42
    v_lshlrev_b32 v18, 16, v43
    v_and_b32 v19, 0xffff0000, v43
    s_waitcnt vmcnt(2)
    v_sub_f32 v68, v16, v50
    v_sub_f32 v69, v17, v50
    v_sub_f32 v70, v18, v50
    v_sub_f32 v71, v19, v50
    v_cvt_pk_bf16_f32 v72, v68, v69
    v_cvt_pk_bf16_f32 v73, v70, v71
    v_lshlrev_b32 v68, 16, v72
    v_and_b32 v69, 0xffff0000, v72
    v_lshlrev_b32 v70, 16, v73
    v_and_b32 v71, 0xffff0000, v73
    v_mul_f32 v68, v68, v51
    v_mul_f32 v69, v69, v51
    v_mul_f32 v70, v70, v51
    v_mul_f32 v71, v71, v51
    v_cvt_pk_bf16_f32 v72, v68, v69
    v_cvt_pk_bf16_f32 v73, v70, v71
    v_lshlrev_b32 v68, 16, v72
    v_and_b32 v69, 0xffff0000, v72
    v_lshlrev_b32 v70, 16, v73
    v_and_b32 v71, 0xffff0000, v73
    v_mul_f32 v68, v68, v60
    v_mul_f32 v69, v69, v61
    v_mul_f32 v70, v70, v62
    v_mul_f32 v71, v71, v63
    v_cvt_pk_bf16_f32 v72, v68, v69
    v_cvt_pk_bf16_f32 v73, v70, v71
    v_lshlrev_b32 v68, 16, v72
    v_and_b32 v69, 0xffff0000, v72
    v_lshlrev_b32 v70, 16, v73
    v_and_b32 v71, 0xffff0000, v73
    v_add_f32 v16, v16, v68
    v_add_f32 v16, v16, v64
    v_add_f32 v17, v17, v69
    v_add_f32 v17, v17, v65
    v_add_f32 v18, v18, v70
    v_add_f32 v18, v18, v66
    v_add_f32 v19, v19, v71
    v_add_f32 v19, v19, v67
    v_lshlrev_b32 v20, 16, v44
    v_and_b32 v21, 0xffff0000, v44
    v_lshlrev_b32 v22, 16, v45
    v_and_b32 v23, 0xffff0000, v45
    s_waitcnt vmcnt(1)
    v_sub_f32 v68, v20, v52
    v_sub_f32 v69, v21, v52
    v_sub_f32 v70, v22, v52
    v_sub_f32 v71, v23, v52
    v_cvt_pk_bf16_f32 v72, v68, v69
    v_cvt_pk_bf16_f32 v73, v70, v71
    v_lshlrev_b32 v68, 16, v72
    v_and_b32 v69, 0xffff0000, v72
    v_lshlrev_b32 v70, 16, v73
    v_and_b32 v71, 0xffff0000, v73
    v_mul_f32 v68, v68, v53
    v_mul_f32 v69, v69, v53
    v_mul_f32 v70, v70, v53
    v_mul_f32 v71, v71, v53
    v_cvt_pk_bf16_f32 v72, v68, v69
    v_cvt_pk_bf16_f32 v73, v70, v71
    v_lshlrev_b32 v68, 16, v72
    v_and_b32 v69, 0xffff0000, v72
    v_lshlrev_b32 v70, 16, v73
    v_and_b32 v71, 0xffff0000, v73
    v_mul_f32 v68, v68, v60
    v_mul_f32 v69, v69, v61
    v_mul_f32 v70, v70, v62
    v_mul_f32 v71, v71, v63
    v_cvt_pk_bf16_f32 v72, v68, v69
    v_cvt_pk_bf16_f32 v73, v70, v71
    v_lshlrev_b32 v68, 16, v72
    v_and_b32 v69, 0xffff0000, v72
    v_lshlrev_b32 v70, 16, v73
    v_and_b32 v71, 0xffff0000, v73
    v_add_f32 v20, v20, v68
    v_add_f32 v20, v20, v64
    v_add_f32 v21, v21, v69
    v_add_f32 v21, v21, v65
    v_add_f32 v22, v22, v70
    v_add_f32 v22, v22, v66
    v_add_f32 v23, v23, v71
    v_add_f32 v23, v23, v67
    v_lshlrev_b32 v24, 16, v46
    v_and_b32 v25, 0xffff0000, v46
    v_lshlrev_b32 v26, 16, v47
    v_and_b32 v27, 0xffff0000, v47
    s_waitcnt vmcnt(0)
    v_sub_f32 v68, v24, v54
    v_sub_f32 v69, v25, v54
    v_sub_f32 v70, v26, v54
    v_sub_f32 v71, v27, v54
    v_cvt_pk_bf16_f32 v72, v68, v69
    v_cvt_pk_bf16_f32 v73, v70, v71
    v_lshlrev_b32 v68, 16, v72
    v_and_b32 v69, 0xffff0000, v72
    v_lshlrev_b32 v70, 16, v73
    v_and_b32 v71, 0xffff0000, v73
    v_mul_f32 v68, v68, v55
    v_mul_f32 v69, v69, v55
    v_mul_f32 v70, v70, v55
    v_mul_f32 v71, v71, v55
    v_cvt_pk_bf16_f32 v72, v68, v69
    v_cvt_pk_bf16_f32 v73, v70, v71
    v_lshlrev_b32 v68, 16, v72
    v_and_b32 v69, 0xffff0000, v72
    v_lshlrev_b32 v70, 16, v73
    v_and_b32 v71, 0xffff0000, v73
    v_mul_f32 v68, v68, v60
    v_mul_f32 v69, v69, v61
    v_mul_f32 v70, v70, v62
    v_mul_f32 v71, v71, v63
    v_cvt_pk_bf16_f32 v72, v68, v69
    v_cvt_pk_bf16_f32 v73, v70, v71
    v_lshlrev_b32 v68, 16, v72
    v_and_b32 v69, 0xffff0000, v72
    v_lshlrev_b32 v70, 16, v73
    v_and_b32 v71, 0xffff0000, v73
    v_add_f32 v24, v24, v68
    v_add_f32 v24, v24, v64
    v_add_f32 v25, v25, v69
    v_add_f32 v25, v25, v65
    v_add_f32 v26, v26, v70
    v_add_f32 v26, v26, v66
    v_add_f32 v27, v27, v71
    v_add_f32 v27, v27, v67
    s_waitcnt vmcnt(10) lgkmcnt(0)
    s_barrier
    ds_read_b128 v[40:43], v4 offset:24576
    ds_read_b128 v[44:47], v4 offset:25600
    ds_read_b128 v[48:51], v4 offset:0
    ds_read_b128 v[52:55], v4 offset:1024
    ds_read_b128 v[56:59], v4 offset:26624
    ds_read_b128 v[60:63], v4 offset:27648
    ds_read_b128 v[64:67], v4 offset:2048
    ds_read_b128 v[68:71], v4 offset:3072
    s_waitcnt vmcnt(10) lgkmcnt(0)
    s_barrier
    v_mfma_f32_32x32x16_bf16 a[0:15], v[48:51], v[40:43], 0
    ds_read_b128 v[72:75], v4 offset:28672
    ds_read_b128 v[76:79], v4 offset:29696
    v_mfma_f32_32x32x16_bf16 a[16:31], v[48:51], v[44:47], 0
    ds_read_b128 v[80:83], v4 offset:4096
    ds_read_b128 v[84:87], v4 offset:5120
    v_mfma_f32_32x32x16_bf16 a[32:47], v[52:55], v[40:43], 0
    ds_read_b128 v[88:91], v4 offset:30720
    ds_read_b128 v[92:95], v4 offset:31744
    v_mfma_f32_32x32x16_bf16 a[48:63], v[52:55], v[44:47], 0
    ds_read_b128 v[96:99], v4 offset:6144
    ds_read_b128 v[100:103], v4 offset:7168
    v_mfma_f32_32x32x16_bf16 a[0:15], v[64:67], v[56:59], a[0:15]
    s_add_u32 m0, s58, 0
    s_add_u32 s59, s57, 24576
    buffer_load_dwordx4 v3, s[68:71], s59 offen lds
    v_mfma_f32_32x32x16_bf16 a[16:31], v[64:67], v[60:63], a[16:31]
    s_add_u32 m0, s58, 1024
    s_add_u32 s59, s57, 25600
    buffer_load_dwordx4 v3, s[68:71], s59 offen lds
    v_mfma_f32_32x32x16_bf16 a[32:47], v[68:71], v[56:59], a[32:47]
    s_add_u32 m0, s58, 2048
    s_add_u32 s59, s57, 26624
    buffer_load_dwordx4 v3, s[68:71], s59 offen lds
    v_mfma_f32_32x32x16_bf16 a[48:63], v[68:71], v[60:63], a[48:63]
    s_add_u32 m0, s58, 3072
    s_add_u32 s59, s57, 27648
    buffer_load_dwordx4 v3, s[68:71], s59 offen lds
    s_waitcnt vmcnt(14) lgkmcnt(0)
    s_barrier
    v_mfma_f32_32x32x16_bf16 a[0:15], v[80:83], v[72:75], a[0:15]
    ds_read_b128 v[40:43], v4 offset:32768
    ds_read_b128 v[44:47], v4 offset:33792
    v_mfma_f32_32x32x16_bf16 a[16:31], v[80:83], v[76:79], a[16:31]
    ds_read_b128 v[48:51], v4 offset:8192
    ds_read_b128 v[52:55], v4 offset:9216
    v_mfma_f32_32x32x16_bf16 a[32:47], v[84:87], v[72:75], a[32:47]
    ds_read_b128 v[56:59], v4 offset:34816
    ds_read_b128 v[60:63], v4 offset:35840
    v_mfma_f32_32x32x16_bf16 a[48:63], v[84:87], v[76:79], a[48:63]
    ds_read_b128 v[64:67], v4 offset:10240
    ds_read_b128 v[68:71], v4 offset:11264
    v_mfma_f32_32x32x16_bf16 a[0:15], v[96:99], v[88:91], a[0:15]
    s_add_u32 m0, s58, 4096
    s_add_u32 s59, s57, 28672
    buffer_load_dwordx4 v3, s[68:71], s59 offen lds
    v_mfma_f32_32x32x16_bf16 a[16:31], v[96:99], v[92:95], a[16:31]
    s_add_u32 m0, s58, 5120
    s_add_u32 s59, s57, 29696
    buffer_load_dwordx4 v3, s[68:71], s59 offen lds
    v_mfma_f32_32x32x16_bf16 a[32:47], v[100:103], v[88:91], a[32:47]
    s_add_u32 m0, s58, 6144
    s_add_u32 s59, s57, 30720
    buffer_load_dwordx4 v3, s[68:71], s59 offen lds
    v_mfma_f32_32x32x16_bf16 a[48:63], v[100:103], v[92:95], a[48:63]
    s_add_u32 m0, s58, 7168
    s_add_u32 s59, s57, 31744
    buffer_load_dwordx4 v3, s[68:71], s59 offen lds
    s_waitcnt vmcnt(18) lgkmcnt(0)
    s_barrier
    v_mfma_f32_32x32x16_bf16 a[0:15], v[48:51], v[40:43], a[0:15]
    ds_read_b128 v[72:75], v4 offset:36864
    ds_read_b128 v[76:79], v4 offset:37888
    v_mfma_f32_32x32x16_bf16 a[16:31], v[48:51], v[44:47], a[16:31]
    ds_read_b128 v[80:83], v4 offset:12288
    ds_read_b128 v[84:87], v4 offset:13312
    v_mfma_f32_32x32x16_bf16 a[32:47], v[52:55], v[40:43], a[32:47]
    ds_read_b128 v[88:91], v4 offset:38912
    ds_read_b128 v[92:95], v4 offset:39936
    v_mfma_f32_32x32x16_bf16 a[48:63], v[52:55], v[44:47], a[48:63]
    ds_read_b128 v[96:99], v4 offset:14336
    ds_read_b128 v[100:103], v4 offset:15360
    v_mfma_f32_32x32x16_bf16 a[0:15], v[64:67], v[56:59], a[0:15]
    s_add_u32 m0, s58, 8192
    s_add_u32 s59, s57, 32768
    buffer_load_dwordx4 v3, s[68:71], s59 offen lds
    v_mfma_f32_32x32x16_bf16 a[16:31], v[64:67], v[60:63], a[16:31]
    s_add_u32 m0, s58, 9216
    s_add_u32 s59, s57, 33792
    buffer_load_dwordx4 v3, s[68:71], s59 offen lds
    v_mfma_f32_32x32x16_bf16 a[32:47], v[68:71], v[56:59], a[32:47]
    s_add_u32 m0, s58, 10240
    s_add_u32 s59, s57, 34816
    buffer_load_dwordx4 v3, s[68:71], s59 offen lds
    v_mfma_f32_32x32x16_bf16 a[48:63], v[68:71], v[60:63], a[48:63]
    s_add_u32 m0, s58, 11264
    s_add_u32 s59, s57, 35840
    buffer_load_dwordx4 v3, s[68:71], s59 offen lds
    s_waitcnt vmcnt(22) lgkmcnt(0)
    s_barrier
    v_mfma_f32_32x32x16_bf16 a[0:15], v[80:83], v[72:75], a[0:15]
    ds_read_b128 v[40:43], v4 offset:24576
    ds_read_b128 v[44:47], v4 offset:25600
    v_mfma_f32_32x32x16_bf16 a[16:31], v[80:83], v[76:79], a[16:31]
    ds_read_b128 v[48:51], v4 offset:16384
    ds_read_b128 v[52:55], v4 offset:17408
    v_mfma_f32_32x32x16_bf16 a[32:47], v[84:87], v[72:75], a[32:47]
    ds_read_b128 v[56:59], v4 offset:26624
    ds_read_b128 v[60:63], v4 offset:27648
    v_mfma_f32_32x32x16_bf16 a[48:63], v[84:87], v[76:79], a[48:63]
    ds_read_b128 v[64:67], v4 offset:18432
    ds_read_b128 v[68:71], v4 offset:19456
    v_mfma_f32_32x32x16_bf16 a[0:15], v[96:99], v[88:91], a[0:15]
    s_add_u32 m0, s58, 12288
    s_add_u32 s59, s57, 36864
    buffer_load_dwordx4 v3, s[68:71], s59 offen lds
    v_mfma_f32_32x32x16_bf16 a[16:31], v[96:99], v[92:95], a[16:31]
    s_add_u32 m0, s58, 13312
    s_add_u32 s59, s57, 37888
    buffer_load_dwordx4 v3, s[68:71], s59 offen lds
    v_mfma_f32_32x32x16_bf16 a[32:47], v[100:103], v[88:91], a[32:47]
    s_add_u32 m0, s58, 14336
    s_add_u32 s59, s57, 38912
    buffer_load_dwordx4 v3, s[68:71], s59 offen lds
    v_mfma_f32_32x32x16_bf16 a[48:63], v[100:103], v[92:95], a[48:63]
    s_add_u32 m0, s58, 15360
    s_add_u32 s59, s57, 39936
    buffer_load_dwordx4 v3, s[68:71], s59 offen lds
    s_waitcnt vmcnt(26) lgkmcnt(0)
    s_barrier
    v_mfma_f32_32x32x16_bf16 a[0:15], v[48:51], v[40:43], a[0:15]
    ds_read_b128 v[72:75], v4 offset:28672
    ds_read_b128 v[76:79], v4 offset:29696
    v_mfma_f32_32x32x16_bf16 a[16:31], v[48:51], v[44:47], a[16:31]
    ds_read_b128 v[80:83], v4 offset:20480
    ds_read_b128 v[84:87], v4 offset:21504
    v_mfma_f32_32x32x16_bf16 a[32:47], v[52:55], v[40:43], a[32:47]
    ds_read_b128 v[88:91], v4 offset:30720
    ds_read_b128 v[92:95], v4 offset:31744
    v_mfma_f32_32x32x16_bf16 a[48:63], v[52:55], v[44:47], a[48:63]
    ds_read_b128 v[96:99], v4 offset:22528
    ds_read_b128 v[100:103], v4 offset:23552
    v_mfma_f32_32x32x16_bf16 a[0:15], v[64:67], v[56:59], a[0:15]
    s_add_u32 m0, s58, 16384
    s_add_u32 s59, s57, 40960
    buffer_load_dwordx4 v3, s[68:71], s59 offen lds
    v_mfma_f32_32x32x16_bf16 a[16:31], v[64:67], v[60:63], a[16:31]
    s_add_u32 m0, s58, 17408
    s_add_u32 s59, s57, 41984
    buffer_load_dwordx4 v3, s[68:71], s59 offen lds
    v_mfma_f32_32x32x16_bf16 a[32:47], v[68:71], v[56:59], a[32:47]
    s_add_u32 m0, s58, 18432
    s_add_u32 s59, s57, 43008
    buffer_load_dwordx4 v3, s[68:71], s59 offen lds
    v_mfma_f32_32x32x16_bf16 a[48:63], v[68:71], v[60:63], a[48:63]
    s_add_u32 m0, s58, 19456
    s_add_u32 s59, s57, 44032
    buffer_load_dwordx4 v3, s[68:71], s59 offen lds
    s_waitcnt vmcnt(16) lgkmcnt(0)
    s_barrier
    v_mfma_f32_32x32x16_bf16 a[0:15], v[80:83], v[72:75], a[0:15]
    ds_read_b128 v[40:43], v4 offset:32768
    ds_read_b128 v[44:47], v4 offset:33792
    v_mfma_f32_32x32x16_bf16 a[16:31], v[80:83], v[76:79], a[16:31]
    ds_read_b128 v[48:51], v4 offset:0
    ds_read_b128 v[52:55], v4 offset:1024
    v_mfma_f32_32x32x16_bf16 a[32:47], v[84:87], v[72:75], a[32:47]
    ds_read_b128 v[56:59], v4 offset:34816
    ds_read_b128 v[60:63], v4 offset:35840
    v_mfma_f32_32x32x16_bf16 a[48:63], v[84:87], v[76:79], a[48:63]
    ds_read_b128 v[64:67], v4 offset:2048
    ds_read_b128 v[68:71], v4 offset:3072
    v_mfma_f32_32x32x16_bf16 a[0:15], v[96:99], v[88:91], a[0:15]
    s_add_u32 m0, s58, 20480
    s_add_u32 s59, s57, 45056
    buffer_load_dwordx4 v3, s[68:71], s59 offen lds
    v_mfma_f32_32x32x16_bf16 a[16:31], v[96:99], v[92:95], a[16:31]
    s_add_u32 m0, s58, 21504
    s_add_u32 s59, s57, 46080
    buffer_load_dwordx4 v3, s[68:71], s59 offen lds
    v_mfma_f32_32x32x16_bf16 a[32:47], v[100:103], v[88:91], a[32:47]
    s_add_u32 m0, s58, 22528
    s_add_u32 s59, s57, 47104
    buffer_load_dwordx4 v3, s[68:71], s59 offen lds
    v_mfma_f32_32x32x16_bf16 a[48:63], v[100:103], v[92:95], a[48:63]
    s_add_u32 m0, s58, 23552
    s_add_u32 s59, s57, 48128
    buffer_load_dwordx4 v3, s[68:71], s59 offen lds
    s_waitcnt vmcnt(16) lgkmcnt(0)
    s_barrier
    v_mfma_f32_32x32x16_bf16 a[0:15], v[48:51], v[40:43], a[0:15]
    ds_read_b128 v[72:75], v4 offset:36864
    ds_read_b128 v[76:79], v4 offset:37888
    v_mfma_f32_32x32x16_bf16 a[16:31], v[48:51], v[44:47], a[16:31]
    ds_read_b128 v[80:83], v4 offset:4096
    ds_read_b128 v[84:87], v4 offset:5120
    v_mfma_f32_32x32x16_bf16 a[32:47], v[52:55], v[40:43], a[32:47]
    ds_read_b128 v[88:91], v4 offset:38912
    ds_read_b128 v[92:95], v4 offset:39936
    v_mfma_f32_32x32x16_bf16 a[48:63], v[52:55], v[44:47], a[48:63]
    ds_read_b128 v[96:99], v4 offset:6144
    ds_read_b128 v[100:103], v4 offset:7168
    v_mfma_f32_32x32x16_bf16 a[0:15], v[64:67], v[56:59], a[0:15]
    s_add_u32 m0, s58, 0
    s_add_u32 s59, s57, 49152
    buffer_load_dwordx4 v3, s[68:71], s59 offen lds
    v_mfma_f32_32x32x16_bf16 a[16:31], v[64:67], v[60:63], a[16:31]
    s_add_u32 m0, s58, 1024
    s_add_u32 s59, s57, 50176
    buffer_load_dwordx4 v3, s[68:71], s59 offen lds
    v_mfma_f32_32x32x16_bf16 a[32:47], v[68:71], v[56:59], a[32:47]
    s_add_u32 m0, s58, 2048
    s_add_u32 s59, s57, 51200
    buffer_load_dwordx4 v3, s[68:71], s59 offen lds
    v_mfma_f32_32x32x16_bf16 a[48:63], v[68:71], v[60:63], a[48:63]
    s_add_u32 m0, s58, 3072
    s_add_u32 s59, s57, 52224
    buffer_load_dwordx4 v3, s[68:71], s59 offen lds
    s_waitcnt vmcnt(16) lgkmcnt(0)
    s_barrier
    v_mfma_f32_32x32x16_bf16 a[0:15], v[80:83], v[72:75], a[0:15]
    ds_read_b128 v[40:43], v4 offset:24576
    ds_read_b128 v[44:47], v4 offset:25600
    v_mfma_f32_32x32x16_bf16 a[16:31], v[80:83], v[76:79], a[16:31]
    ds_read_b128 v[48:51], v4 offset:8192
    ds_read_b128 v[52:55], v4 offset:9216
    v_mfma_f32_32x32x16_bf16 a[32:47], v[84:87], v[72:75], a[32:47]
    ds_read_b128 v[56:59], v4 offset:26624
    ds_read_b128 v[60:63], v4 offset:27648
    v_mfma_f32_32x32x16_bf16 a[48:63], v[84:87], v[76:79], a[48:63]
    ds_read_b128 v[64:67], v4 offset:10240
    ds_read_b128 v[68:71], v4 offset:11264
    v_mfma_f32_32x32x16_bf16 a[0:15], v[96:99], v[88:91], a[0:15]
    s_add_u32 m0, s58, 4096
    s_add_u32 s59, s57, 53248
    buffer_load_dwordx4 v3, s[68:71], s59 offen lds
    v_mfma_f32_32x32x16_bf16 a[16:31], v[96:99], v[92:95], a[16:31]
    s_add_u32 m0, s58, 5120
    s_add_u32 s59, s57, 54272
    buffer_load_dwordx4 v3, s[68:71], s59 offen lds
    v_mfma_f32_32x32x16_bf16 a[32:47], v[100:103], v[88:91], a[32:47]
    s_add_u32 m0, s58, 6144
    s_add_u32 s59, s57, 55296
    buffer_load_dwordx4 v3, s[68:71], s59 offen lds
    v_mfma_f32_32x32x16_bf16 a[48:63], v[100:103], v[92:95], a[48:63]
    s_add_u32 m0, s58, 7168
    s_add_u32 s59, s57, 56320
    buffer_load_dwordx4 v3, s[68:71], s59 offen lds
    s_waitcnt vmcnt(16) lgkmcnt(0)
    s_barrier
    v_mfma_f32_32x32x16_bf16 a[0:15], v[48:51], v[40:43], a[0:15]
    ds_read_b128 v[72:75], v4 offset:28672
    ds_read_b128 v[76:79], v4 offset:29696
    v_mfma_f32_32x32x16_bf16 a[16:31], v[48:51], v[44:47], a[16:31]
    ds_read_b128 v[80:83], v4 offset:12288
    ds_read_b128 v[84:87], v4 offset:13312
    v_mfma_f32_32x32x16_bf16 a[32:47], v[52:55], v[40:43], a[32:47]
    ds_read_b128 v[88:91], v4 offset:30720
    ds_read_b128 v[92:95], v4 offset:31744
    v_mfma_f32_32x32x16_bf16 a[48:63], v[52:55], v[44:47], a[48:63]
    ds_read_b128 v[96:99], v4 offset:14336
    ds_read_b128 v[100:103], v4 offset:15360
    v_mfma_f32_32x32x16_bf16 a[0:15], v[64:67], v[56:59], a[0:15]
    s_add_u32 m0, s58, 8192
    s_add_u32 s59, s57, 57344
    buffer_load_dwordx4 v3, s[68:71], s59 offen lds
    v_mfma_f32_32x32x16_bf16 a[16:31], v[64:67], v[60:63], a[16:31]
    s_add_u32 m0, s58, 9216
    s_add_u32 s59, s57, 58368
    buffer_load_dwordx4 v3, s[68:71], s59 offen lds
    v_mfma_f32_32x32x16_bf16 a[32:47], v[68:71], v[56:59], a[32:47]
    s_add_u32 m0, s58, 10240
    s_add_u32 s59, s57, 59392
    buffer_load_dwordx4 v3, s[68:71], s59 offen lds
    v_mfma_f32_32x32x16_bf16 a[48:63], v[68:71], v[60:63], a[48:63]
    s_add_u32 m0, s58, 11264
    s_add_u32 s59, s57, 60416
    buffer_load_dwordx4 v3, s[68:71], s59 offen lds
    s_waitcnt vmcnt(16) lgkmcnt(0)
    s_barrier
    v_mfma_f32_32x32x16_bf16 a[0:15], v[80:83], v[72:75], a[0:15]
    ds_read_b128 v[40:43], v4 offset:32768
    ds_read_b128 v[44:47], v4 offset:33792
    v_mfma_f32_32x32x16_bf16 a[16:31], v[80:83], v[76:79], a[16:31]
    ds_read_b128 v[48:51], v4 offset:16384
    ds_read_b128 v[52:55], v4 offset:17408
    v_mfma_f32_32x32x16_bf16 a[32:47], v[84:87], v[72:75], a[32:47]
    ds_read_b128 v[56:59], v4 offset:34816
    ds_read_b128 v[60:63], v4 offset:35840
    v_mfma_f32_32x32x16_bf16 a[48:63], v[84:87], v[76:79], a[48:63]
    ds_read_b128 v[64:67], v4 offset:18432
    ds_read_b128 v[68:71], v4 offset:19456
    v_mfma_f32_32x32x16_bf16 a[0:15], v[96:99], v[88:91], a[0:15]
    s_add_u32 m0, s58, 12288
    s_add_u32 s59, s57, 61440
    buffer_load_dwordx4 v3, s[68:71], s59 offen lds
    v_mfma_f32_32x32x16_bf16 a[16:31], v[96:99], v[92:95], a[16:31]
    s_add_u32 m0, s58, 13312
    s_add_u32 s59, s57, 62464
    buffer_load_dwordx4 v3, s[68:71], s59 offen lds
    v_mfma_f32_32x32x16_bf16 a[32:47], v[100:103], v[88:91], a[32:47]
    s_add_u32 m0, s58, 14336
    s_add_u32 s59, s57, 63488
    buffer_load_dwordx4 v3, s[68:71], s59 offen lds
    v_mfma_f32_32x32x16_bf16 a[48:63], v[100:103], v[92:95], a[48:63]
    s_add_u32 m0, s58, 15360
    s_add_u32 s59, s57, 64512
    buffer_load_dwordx4 v3, s[68:71], s59 offen lds
    s_waitcnt vmcnt(16) lgkmcnt(0)
    s_barrier
    v_mfma_f32_32x32x16_bf16 a[0:15], v[48:51], v[40:43], a[0:15]
    ds_read_b128 v[72:75], v4 offset:36864
    ds_read_b128 v[76:79], v4 offset:37888
    v_mfma_f32_32x32x16_bf16 a[16:31], v[48:51], v[44:47], a[16:31]
    ds_read_b128 v[80:83], v4 offset:20480
    ds_read_b128 v[84:87], v4 offset:21504
    v_mfma_f32_32x32x16_bf16 a[32:47], v[52:55], v[40:43], a[32:47]
    ds_read_b128 v[88:91], v4 offset:38912
    ds_read_b128 v[92:95], v4 offset:39936
    v_mfma_f32_32x32x16_bf16 a[48:63], v[52:55], v[44:47], a[48:63]
    ds_read_b128 v[96:99], v4 offset:22528
    ds_read_b128 v[100:103], v4 offset:23552
    v_mfma_f32_32x32x16_bf16 a[0:15], v[64:67], v[56:59], a[0:15]
    s_add_u32 m0, s58, 16384
    s_add_u32 s59, s57, 65536
    buffer_load_dwordx4 v3, s[68:71], s59 offen lds
    v_mfma_f32_32x32x16_bf16 a[16:31], v[64:67], v[60:63], a[16:31]
    s_add_u32 m0, s58, 17408
    s_add_u32 s59, s57, 66560
    buffer_load_dwordx4 v3, s[68:71], s59 offen lds
    v_mfma_f32_32x32x16_bf16 a[32:47], v[68:71], v[56:59], a[32:47]
    s_add_u32 m0, s58, 18432
    s_add_u32 s59, s57, 67584
    buffer_load_dwordx4 v3, s[68:71], s59 offen lds
    v_mfma_f32_32x32x16_bf16 a[48:63], v[68:71], v[60:63], a[48:63]
    s_add_u32 m0, s58, 19456
    s_add_u32 s59, s57, 68608
    buffer_load_dwordx4 v3, s[68:71], s59 offen lds
    s_waitcnt vmcnt(16) lgkmcnt(0)
    s_barrier
    v_mfma_f32_32x32x16_bf16 a[0:15], v[80:83], v[72:75], a[0:15]
    ds_read_b128 v[40:43], v4 offset:24576
    ds_read_b128 v[44:47], v4 offset:25600
    v_mfma_f32_32x32x16_bf16 a[16:31], v[80:83], v[76:79], a[16:31]
    ds_read_b128 v[48:51], v4 offset:0
    ds_read_b128 v[52:55], v4 offset:1024
    v_mfma_f32_32x32x16_bf16 a[32:47], v[84:87], v[72:75], a[32:47]
    ds_read_b128 v[56:59], v4 offset:26624
    ds_read_b128 v[60:63], v4 offset:27648
    v_mfma_f32_32x32x16_bf16 a[48:63], v[84:87], v[76:79], a[48:63]
    ds_read_b128 v[64:67], v4 offset:2048
    ds_read_b128 v[68:71], v4 offset:3072
    v_mfma_f32_32x32x16_bf16 a[0:15], v[96:99], v[88:91], a[0:15]
    s_add_u32 m0, s58, 20480
    s_add_u32 s59, s57, 69632
    buffer_load_dwordx4 v3, s[68:71], s59 offen lds
    v_mfma_f32_32x32x16_bf16 a[16:31], v[96:99], v[92:95], a[16:31]
    s_add_u32 m0, s58, 21504
    s_add_u32 s59, s57, 70656
    buffer_load_dwordx4 v3, s[68:71], s59 offen lds
    v_mfma_f32_32x32x16_bf16 a[32:47], v[100:103], v[88:91], a[32:47]
    s_add_u32 m0, s58, 22528
    s_add_u32 s59, s57, 71680
    buffer_load_dwordx4 v3, s[68:71], s59 offen lds
    v_mfma_f32_32x32x16_bf16 a[48:63], v[100:103], v[92:95], a[48:63]
    s_add_u32 m0, s58, 23552
    s_add_u32 s59, s57, 72704
    buffer_load_dwordx4 v3, s[68:71], s59 offen lds
    s_waitcnt vmcnt(16) lgkmcnt(0)
    s_barrier
    v_mfma_f32_32x32x16_bf16 a[0:15], v[48:51], v[40:43], a[0:15]
    ds_read_b128 v[72:75], v4 offset:28672
    ds_read_b128 v[76:79], v4 offset:29696
    v_mfma_f32_32x32x16_bf16 a[16:31], v[48:51], v[44:47], a[16:31]
    ds_read_b128 v[80:83], v4 offset:4096
    ds_read_b128 v[84:87], v4 offset:5120
    v_mfma_f32_32x32x16_bf16 a[32:47], v[52:55], v[40:43], a[32:47]
    ds_read_b128 v[88:91], v4 offset:30720
    ds_read_b128 v[92:95], v4 offset:31744
    v_mfma_f32_32x32x16_bf16 a[48:63], v[52:55], v[44:47], a[48:63]
    ds_read_b128 v[96:99], v4 offset:6144
    ds_read_b128 v[100:103], v4 offset:7168
    v_mfma_f32_32x32x16_bf16 a[0:15], v[64:67], v[56:59], a[0:15]
    s_add_u32 m0, s58, 0
    s_add_u32 s59, s57, 73728
    buffer_load_dwordx4 v3, s[68:71], s59 offen lds
    v_mfma_f32_32x32x16_bf16 a[16:31], v[64:67], v[60:63], a[16:31]
    s_add_u32 m0, s58, 1024
    s_add_u32 s59, s57, 74752
    buffer_load_dwordx4 v3, s[68:71], s59 offen lds
    v_mfma_f32_32x32x16_bf16 a[32:47], v[68:71], v[56:59], a[32:47]
    s_add_u32 m0, s58, 2048
    s_add_u32 s59, s57, 75776
    buffer_load_dwordx4 v3, s[68:71], s59 offen lds
    v_mfma_f32_32x32x16_bf16 a[48:63], v[68:71], v[60:63], a[48:63]
    s_add_u32 m0, s58, 3072
    s_add_u32 s59, s57, 76800
    buffer_load_dwordx4 v3, s[68:71], s59 offen lds
    s_waitcnt vmcnt(16) lgkmcnt(0)
    s_barrier
    v_mfma_f32_32x32x16_bf16 a[0:15], v[80:83], v[72:75], a[0:15]
    ds_read_b128 v[40:43], v4 offset:32768
    ds_read_b128 v[44:47], v4 offset:33792
    v_mfma_f32_32x32x16_bf16 a[16:31], v[80:83], v[76:79], a[16:31]
    ds_read_b128 v[48:51], v4 offset:8192
    ds_read_b128 v[52:55], v4 offset:9216
    v_mfma_f32_32x32x16_bf16 a[32:47], v[84:87], v[72:75], a[32:47]
    ds_read_b128 v[56:59], v4 offset:34816
    ds_read_b128 v[60:63], v4 offset:35840
    v_mfma_f32_32x32x16_bf16 a[48:63], v[84:87], v[76:79], a[48:63]
    ds_read_b128 v[64:67], v4 offset:10240
    ds_read_b128 v[68:71], v4 offset:11264
    v_mfma_f32_32x32x16_bf16 a[0:15], v[96:99], v[88:91], a[0:15]
    s_add_u32 m0, s58, 4096
    s_add_u32 s59, s57, 77824
    buffer_load_dwordx4 v3, s[68:71], s59 offen lds
    v_mfma_f32_32x32x16_bf16 a[16:31], v[96:99], v[92:95], a[16:31]
    s_add_u32 m0, s58, 5120
    s_add_u32 s59, s57, 78848
    buffer_load_dwordx4 v3, s[68:71], s59 offen lds
    v_mfma_f32_32x32x16_bf16 a[32:47], v[100:103], v[88:91], a[32:47]
    s_add_u32 m0, s58, 6144
    s_add_u32 s59, s57, 79872
    buffer_load_dwordx4 v3, s[68:71], s59 offen lds
    v_mfma_f32_32x32x16_bf16 a[48:63], v[100:103], v[92:95], a[48:63]
    s_add_u32 m0, s58, 7168
    s_add_u32 s59, s57, 80896
    buffer_load_dwordx4 v3, s[68:71], s59 offen lds
    s_waitcnt vmcnt(16) lgkmcnt(0)
    s_barrier
    v_mfma_f32_32x32x16_bf16 a[0:15], v[48:51], v[40:43], a[0:15]
    ds_read_b128 v[72:75], v4 offset:36864
    ds_read_b128 v[76:79], v4 offset:37888
    v_mfma_f32_32x32x16_bf16 a[16:31], v[48:51], v[44:47], a[16:31]
    ds_read_b128 v[80:83], v4 offset:12288
    ds_read_b128 v[84:87], v4 offset:13312
    v_mfma_f32_32x32x16_bf16 a[32:47], v[52:55], v[40:43], a[32:47]
    ds_read_b128 v[88:91], v4 offset:38912
    ds_read_b128 v[92:95], v4 offset:39936
    v_mfma_f32_32x32x16_bf16 a[48:63], v[52:55], v[44:47], a[48:63]
    ds_read_b128 v[96:99], v4 offset:14336
    ds_read_b128 v[100:103], v4 offset:15360
    v_mfma_f32_32x32x16_bf16 a[0:15], v[64:67], v[56:59], a[0:15]
    s_add_u32 m0, s58, 8192
    s_add_u32 s59, s57, 81920
    buffer_load_dwordx4 v3, s[68:71], s59 offen lds
    v_mfma_f32_32x32x16_bf16 a[16:31], v[64:67], v[60:63], a[16:31]
    s_add_u32 m0, s58, 9216
    s_add_u32 s59, s57, 82944
    buffer_load_dwordx4 v3, s[68:71], s59 offen lds
    v_mfma_f32_32x32x16_bf16 a[32:47], v[68:71], v[56:59], a[32:47]
    s_add_u32 m0, s58, 10240
    s_add_u32 s59, s57, 83968
    buffer_load_dwordx4 v3, s[68:71], s59 offen lds
    v_mfma_f32_32x32x16_bf16 a[48:63], v[68:71], v[60:63], a[48:63]
    s_add_u32 m0, s58, 11264
    s_add_u32 s59, s57, 84992
    buffer_load_dwordx4 v3, s[68:71], s59 offen lds
    s_waitcnt vmcnt(16) lgkmcnt(0)
    s_barrier
    v_mfma_f32_32x32x16_bf16 a[0:15], v[80:83], v[72:75], a[0:15]
    ds_read_b128 v[40:43], v4 offset:24576
    ds_read_b128 v[44:47], v4 offset:25600
    v_mfma_f32_32x32x16_bf16 a[16:31], v[80:83], v[76:79], a[16:31]
    ds_read_b128 v[48:51], v4 offset:16384
    ds_read_b128 v[52:55], v4 offset:17408
    v_mfma_f32_32x32x16_bf16 a[32:47], v[84:87], v[72:75], a[32:47]
    ds_read_b128 v[56:59], v4 offset:26624
    ds_read_b128 v[60:63], v4 offset:27648
    v_mfma_f32_32x32x16_bf16 a[48:63], v[84:87], v[76:79], a[48:63]
    ds_read_b128 v[64:67], v4 offset:18432
    ds_read_b128 v[68:71], v4 offset:19456
    v_mfma_f32_32x32x16_bf16 a[0:15], v[96:99], v[88:91], a[0:15]
    s_add_u32 m0, s58, 12288
    s_add_u32 s59, s57, 86016
    buffer_load_dwordx4 v3, s[68:71], s59 offen lds
    v_mfma_f32_32x32x16_bf16 a[16:31], v[96:99], v[92:95], a[16:31]
    s_add_u32 m0, s58, 13312
    s_add_u32 s59, s57, 87040
    buffer_load_dwordx4 v3, s[68:71], s59 offen lds
    v_mfma_f32_32x32x16_bf16 a[32:47], v[100:103], v[88:91], a[32:47]
    s_add_u32 m0, s58, 14336
    s_add_u32 s59, s57, 88064
    buffer_load_dwordx4 v3, s[68:71], s59 offen lds
    v_mfma_f32_32x32x16_bf16 a[48:63], v[100:103], v[92:95], a[48:63]
    s_add_u32 m0, s58, 15360
    s_add_u32 s59, s57, 89088
    buffer_load_dwordx4 v3, s[68:71], s59 offen lds
    s_waitcnt vmcnt(16) lgkmcnt(0)
    s_barrier
    v_mfma_f32_32x32x16_bf16 a[0:15], v[48:51], v[40:43], a[0:15]
    ds_read_b128 v[72:75], v4 offset:28672
    ds_read_b128 v[76:79], v4 offset:29696
    v_mfma_f32_32x32x16_bf16 a[16:31], v[48:51], v[44:47], a[16:31]
    ds_read_b128 v[80:83], v4 offset:20480
    ds_read_b128 v[84:87], v4 offset:21504
    v_mfma_f32_32x32x16_bf16 a[32:47], v[52:55], v[40:43], a[32:47]
    ds_read_b128 v[88:91], v4 offset:30720
    ds_read_b128 v[92:95], v4 offset:31744
    v_mfma_f32_32x32x16_bf16 a[48:63], v[52:55], v[44:47], a[48:63]
    ds_read_b128 v[96:99], v4 offset:22528
    ds_read_b128 v[100:103], v4 offset:23552
    v_mfma_f32_32x32x16_bf16 a[0:15], v[64:67], v[56:59], a[0:15]
    v_mfma_f32_32x32x16_bf16 a[16:31], v[64:67], v[60:63], a[16:31]
    v_mfma_f32_32x32x16_bf16 a[32:47], v[68:71], v[56:59], a[32:47]
    v_mfma_f32_32x32x16_bf16 a[48:63], v[68:71], v[60:63], a[48:63]
    s_waitcnt vmcnt(12) lgkmcnt(0)
    s_barrier
    v_mfma_f32_32x32x16_bf16 a[0:15], v[80:83], v[72:75], a[0:15]
    ds_read_b128 v[40:43], v4 offset:32768
    ds_read_b128 v[44:47], v4 offset:33792
    v_mfma_f32_32x32x16_bf16 a[16:31], v[80:83], v[76:79], a[16:31]
    ds_read_b128 v[48:51], v4 offset:0
    ds_read_b128 v[52:55], v4 offset:1024
    v_mfma_f32_32x32x16_bf16 a[32:47], v[84:87], v[72:75], a[32:47]
    ds_read_b128 v[56:59], v4 offset:34816
    ds_read_b128 v[60:63], v4 offset:35840
    v_mfma_f32_32x32x16_bf16 a[48:63], v[84:87], v[76:79], a[48:63]
    ds_read_b128 v[64:67], v4 offset:2048
    ds_read_b128 v[68:71], v4 offset:3072
    v_mfma_f32_32x32x16_bf16 a[0:15], v[96:99], v[88:91], a[0:15]
    v_mfma_f32_32x32x16_bf16 a[16:31], v[96:99], v[92:95], a[16:31]
    v_mfma_f32_32x32x16_bf16 a[32:47], v[100:103], v[88:91], a[32:47]
    v_mfma_f32_32x32x16_bf16 a[48:63], v[100:103], v[92:95], a[48:63]
    s_waitcnt vmcnt(8) lgkmcnt(0)
    s_barrier
    v_mfma_f32_32x32x16_bf16 a[0:15], v[48:51], v[40:43], a[0:15]
    ds_read_b128 v[72:75], v4 offset:36864
    ds_read_b128 v[76:79], v4 offset:37888
    v_mfma_f32_32x32x16_bf16 a[16:31], v[48:51], v[44:47], a[16:31]
    ds_read_b128 v[80:83], v4 offset:4096
    ds_read_b128 v[84:87], v4 offset:5120
    v_mfma_f32_32x32x16_bf16 a[32:47], v[52:55], v[40:43], a[32:47]
    ds_read_b128 v[88:91], v4 offset:38912
    ds_read_b128 v[92:95], v4 offset:39936
    v_mfma_f32_32x32x16_bf16 a[48:63], v[52:55], v[44:47], a[48:63]
    ds_read_b128 v[96:99], v4 offset:6144
    ds_read_b128 v[100:103], v4 offset:7168
    v_mfma_f32_32x32x16_bf16 a[0:15], v[64:67], v[56:59], a[0:15]
    v_mfma_f32_32x32x16_bf16 a[16:31], v[64:67], v[60:63], a[16:31]
    v_mfma_f32_32x32x16_bf16 a[32:47], v[68:71], v[56:59], a[32:47]
    v_mfma_f32_32x32x16_bf16 a[48:63], v[68:71], v[60:63], a[48:63]
    s_waitcnt vmcnt(4) lgkmcnt(0)
    s_barrier
    v_mfma_f32_32x32x16_bf16 a[0:15], v[80:83], v[72:75], a[0:15]
    ds_read_b128 v[40:43], v4 offset:24576
    ds_read_b128 v[44:47], v4 offset:25600
    v_mfma_f32_32x32x16_bf16 a[16:31], v[80:83], v[76:79], a[16:31]
    ds_read_b128 v[48:51], v4 offset:8192
    ds_read_b128 v[52:55], v4 offset:9216
    v_mfma_f32_32x32x16_bf16 a[32:47], v[84:87], v[72:75], a[32:47]
    ds_read_b128 v[56:59], v4 offset:26624
    ds_read_b128 v[60:63], v4 offset:27648
    v_mfma_f32_32x32x16_bf16 a[48:63], v[84:87], v[76:79], a[48:63]
    ds_read_b128 v[64:67], v4 offset:10240
    ds_read_b128 v[68:71], v4 offset:11264
    v_mfma_f32_32x32x16_bf16 a[0:15], v[96:99], v[88:91], a[0:15]
    v_mfma_f32_32x32x16_bf16 a[16:31], v[96:99], v[92:95], a[16:31]
    v_mfma_f32_32x32x16_bf16 a[32:47], v[100:103], v[88:91], a[32:47]
    v_mfma_f32_32x32x16_bf16 a[48:63], v[100:103], v[92:95], a[48:63]
    s_waitcnt vmcnt(0) lgkmcnt(0)
    s_barrier
    v_mfma_f32_32x32x16_bf16 a[0:15], v[48:51], v[40:43], a[0:15]
    ds_read_b128 v[72:75], v4 offset:28672
    ds_read_b128 v[76:79], v4 offset:29696
    v_mfma_f32_32x32x16_bf16 a[16:31], v[48:51], v[44:47], a[16:31]
    ds_read_b128 v[80:83], v4 offset:12288
    ds_read_b128 v[84:87], v4 offset:13312
    v_mfma_f32_32x32x16_bf16 a[32:47], v[52:55], v[40:43], a[32:47]
    ds_read_b128 v[88:91], v4 offset:30720
    ds_read_b128 v[92:95], v4 offset:31744
    v_mfma_f32_32x32x16_bf16 a[48:63], v[52:55], v[44:47], a[48:63]
    ds_read_b128 v[96:99], v4 offset:14336
    ds_read_b128 v[100:103], v4 offset:15360
    v_mfma_f32_32x32x16_bf16 a[0:15], v[64:67], v[56:59], a[0:15]
    v_mfma_f32_32x32x16_bf16 a[16:31], v[64:67], v[60:63], a[16:31]
    v_mfma_f32_32x32x16_bf16 a[32:47], v[68:71], v[56:59], a[32:47]
    v_mfma_f32_32x32x16_bf16 a[48:63], v[68:71], v[60:63], a[48:63]
    s_waitcnt lgkmcnt(0)
    v_mfma_f32_32x32x16_bf16 a[0:15], v[80:83], v[72:75], a[0:15]
    v_mfma_f32_32x32x16_bf16 a[16:31], v[80:83], v[76:79], a[16:31]
    v_mfma_f32_32x32x16_bf16 a[32:47], v[84:87], v[72:75], a[32:47]
    v_mfma_f32_32x32x16_bf16 a[48:63], v[84:87], v[76:79], a[48:63]
    v_mfma_f32_32x32x16_bf16 a[0:15], v[96:99], v[88:91], a[0:15]
    v_mfma_f32_32x32x16_bf16 a[16:31], v[96:99], v[92:95], a[16:31]
    v_mfma_f32_32x32x16_bf16 a[32:47], v[100:103], v[88:91], a[32:47]
    v_mfma_f32_32x32x16_bf16 a[48:63], v[100:103], v[92:95], a[48:63]
    s_nop 8
    ds_write_b128 v28, a[0:3] offset:0
    ds_write_b128 v29, a[4:7] offset:0
    ds_write_b128 v30, a[8:11] offset:0
    ds_write_b128 v31, a[12:15] offset:0
    ds_write_b128 v28, a[16:19] offset:8192
    ds_write_b128 v29, a[20:23] offset:8192
    ds_write_b128 v30, a[24:27] offset:8192
    ds_write_b128 v31, a[28:31] offset:8192
    ds_write_b128 v28, a[32:35] offset:128
    ds_write_b128 v29, a[36:39] offset:128
    ds_write_b128 v30, a[40:43] offset:128
    ds_write_b128 v31, a[44:47] offset:128
    ds_write_b128 v28, a[48:51] offset:8320
    ds_write_b128 v29, a[52:55] offset:8320
    ds_write_b128 v30, a[56:59] offset:8320
    ds_write_b128 v31, a[60:63] offset:8320
    s_waitcnt lgkmcnt(0)
    s_barrier
    ds_read_b128 v[40:43], v32 offset:0
    ds_read_b128 v[44:47], v32 offset:40960
    ds_read_b128 v[48:51], v33 offset:0
    ds_read_b128 v[52:55], v33 offset:40960
    ds_read_b128 v[56:59], v32 offset:1024
    ds_read_b128 v[60:63], v32 offset:41984
    ds_read_b128 v[64:67], v33 offset:1024
    ds_read_b128 v[68:71], v33 offset:41984
    ds_read_b128 v[72:75], v32 offset:2048
    ds_read_b128 v[76:79], v32 offset:43008
    ds_read_b128 v[80:83], v33 offset:2048
    ds_read_b128 v[84:87], v33 offset:43008
    ds_read_b128 v[88:91], v32 offset:3072
    ds_read_b128 v[92:95], v32 offset:44032
    ds_read_b128 v[96:99], v33 offset:3072
    ds_read_b128 v[100:103], v33 offset:44032
    s_waitcnt lgkmcnt(15)
    v_add_f32 v12, v12, v40
    v_add_f32 v13, v13, v41
    v_add_f32 v14, v14, v42
    v_add_f32 v15, v15, v43
    s_waitcnt lgkmcnt(14)
    v_add_f32 v12, v12, v44
    v_add_f32 v13, v13, v45
    v_add_f32 v14, v14, v46
    v_add_f32 v15, v15, v47
    s_waitcnt lgkmcnt(13)
    v_add_f32 v12, v12, v48
    v_add_f32 v13, v13, v49
    v_add_f32 v14, v14, v50
    v_add_f32 v15, v15, v51
    s_waitcnt lgkmcnt(12)
    v_add_f32 v12, v12, v52
    v_add_f32 v13, v13, v53
    v_add_f32 v14, v14, v54
    v_add_f32 v15, v15, v55
    s_mov_b32 s54, 0
    buffer_store_dwordx4 v[12:15], v11, s[44:47], s54 offen sc0 sc1
    s_waitcnt lgkmcnt(11)
    v_add_f32 v16, v16, v56
    v_add_f32 v17, v17, v57
    v_add_f32 v18, v18, v58
    v_add_f32 v19, v19, v59
    s_waitcnt lgkmcnt(10)
    v_add_f32 v16, v16, v60
    v_add_f32 v17, v17, v61
    v_add_f32 v18, v18, v62
    v_add_f32 v19, v19, v63
    s_waitcnt lgkmcnt(9)
    v_add_f32 v16, v16, v64
    v_add_f32 v17, v17, v65
    v_add_f32 v18, v18, v66
    v_add_f32 v19, v19, v67
    s_waitcnt lgkmcnt(8)
    v_add_f32 v16, v16, v68
    v_add_f32 v17, v17, v69
    v_add_f32 v18, v18, v70
    v_add_f32 v19, v19, v71
    s_mov_b32 s54, 8192
    buffer_store_dwordx4 v[16:19], v11, s[44:47], s54 offen sc0 sc1
    s_waitcnt lgkmcnt(7)
    v_add_f32 v20, v20, v72
    v_add_f32 v21, v21, v73
    v_add_f32 v22, v22, v74
    v_add_f32 v23, v23, v75
    s_waitcnt lgkmcnt(6)
    v_add_f32 v20, v20, v76
    v_add_f32 v21, v21, v77
    v_add_f32 v22, v22, v78
    v_add_f32 v23, v23, v79
    s_waitcnt lgkmcnt(5)
    v_add_f32 v20, v20, v80
    v_add_f32 v21, v21, v81
    v_add_f32 v22, v22, v82
    v_add_f32 v23, v23, v83
    s_waitcnt lgkmcnt(4)
    v_add_f32 v20, v20, v84
    v_add_f32 v21, v21, v85
    v_add_f32 v22, v22, v86
    v_add_f32 v23, v23, v87
    s_mov_b32 s54, 16384
    buffer_store_dwordx4 v[20:23], v11, s[44:47], s54 offen sc0 sc1
    s_waitcnt lgkmcnt(3)
    v_add_f32 v24, v24, v88
    v_add_f32 v25, v25, v89
    v_add_f32 v26, v26, v90
    v_add_f32 v27, v27, v91
    s_waitcnt lgkmcnt(2)
    v_add_f32 v24, v24, v92
    v_add_f32 v25, v25, v93
    v_add_f32 v26, v26, v94
    v_add_f32 v27, v27, v95
    s_waitcnt lgkmcnt(1)
    v_add_f32 v24, v24, v96
    v_add_f32 v25, v25, v97
    v_add_f32 v26, v26, v98
    v_add_f32 v27, v27, v99
    s_waitcnt lgkmcnt(0)
    v_add_f32 v24, v24, v100
    v_add_f32 v25, v25, v101
    v_add_f32 v26, v26, v102
    v_add_f32 v27, v27, v103
    s_mov_b32 s54, 24576
    buffer_store_dwordx4 v[24:27], v11, s[44:47], s54 offen sc0 sc1
parallel_sum__ssm_conv_s5__dense_activation_gelu__prompt_kernel_end:
    s_endpgm

.section .rodata,"a"
.p2align 6
.p2align 6
.amdhsa_kernel parallel_sum__ssm_conv_s5__dense_activation_gelu__prompt_kernel
  .amdhsa_next_free_vgpr 256
  .amdhsa_next_free_sgpr 102
  .amdhsa_accum_offset 128
  .amdhsa_group_segment_fixed_size 0
  .amdhsa_kernarg_size 136
  .amdhsa_user_sgpr_count 2
  .amdhsa_user_sgpr_kernarg_segment_ptr 1
  .amdhsa_system_sgpr_workgroup_id_x 1
.end_amdhsa_kernel
```
